```python
import torch

def _softmax(x, axis=-1):
    return torch.softmax(x, dim=axis)
def _gelu(x):
    return torch.nn.functional.gelu(x, approximate="tanh")
def _silu(x):
    return torch.nn.functional.silu(x)
def _sigmoid(x):
    return torch.sigmoid(x)
def _layernorm(x, axis=-1, eps=1e-5):
    m = x.mean(dim=axis, keepdim=True)
    v = x.var(dim=axis, keepdim=True, unbiased=False)
    return (x - m) / torch.sqrt(v + eps)
def _scatter_add(tgt, idx, src, axis=0):
    return tgt.clone().index_add_(axis, idx, src)
def _segment_sum(src, seg, n):
    out = torch.zeros((n,) + src.shape[1:], dtype=src.dtype)
    return out.index_add_(0, seg, src)
def _pad(x, pw):
    flat = tuple(v for pair in reversed(pw) for v in pair)
    return torch.nn.functional.pad(x, flat)

kernel_name = 'parallel_sum__spectral_gfnet__glu_gated_bilinear__prompt'

def setup_inputs():

    _w = (lambda a: (lambda t: t.to(torch.bfloat16) if t.is_floating_point() else t)(torch.as_tensor(a)))
    def _A_setup():
        B, S, D = 1, 2048, 448
        Df = D // 2 + 1
        return {
            "x": _w((lambda *s: torch.randn(*s, dtype=torch.bfloat16) * 0.05)(B, S, D)),
            "w_r": _w((lambda *s: torch.randn(*s, dtype=torch.bfloat16) * 0.4)(S, Df) * 0.02),
            "w_i": _w((lambda *s: torch.randn(*s, dtype=torch.bfloat16) * 0.4)(S, Df) * 0.02),
        }
    _A_in = _A_setup()

    def _B_setup():
        B, S, D, F = 1, 2048, 448, 1792
        return {
            "x": _w((lambda *s: torch.randn(*s, dtype=torch.bfloat16) * 0.05)(B, S, D)),
            "w_gate": _w((lambda *s: torch.randn(*s, dtype=torch.bfloat16) * 0.2)(D, F) * (D ** -0.5)),
            "w_up": _w((lambda *s: torch.randn(*s, dtype=torch.bfloat16) * 0.2)(D, F) * (D ** -0.5)),
            "w_down": _w((lambda *s: torch.randn(*s, dtype=torch.bfloat16) * 0.2)(F, D) * (F ** -0.5)),
        }
    _B_in = _B_setup()

    return {
        "A_x": _A_in["x"],
        "A_w_r": _A_in["w_r"],
        "A_w_i": _A_in["w_i"],
        "B_x": _B_in["x"],
        "B_w_gate": _B_in["w_gate"],
        "B_w_up": _B_in["w_up"],
        "B_w_down": _B_in["w_down"],
    }

def reference(A_x, A_w_r, A_w_i, B_x, B_w_gate, B_w_up, B_w_down):
    def _A_ref(x, w_r, w_i):
        B, S, D = x.shape
        X = (lambda x, axes=(-2,-1): torch.fft.rfft2(x.float(), dim=axes))(x, axes=(-2, -1))
        W = w_r + 1j * w_i
        X = X * W
        y = (lambda x, s, axes=(-2,-1): torch.fft.irfft2(x, s=s, dim=axes).to(torch.bfloat16))(X, (S, D), axes=(-2, -1))
        return y

    def _B_ref(x, w_gate, w_up, w_down):
        g = torch.einsum("bsd,df->bsf", x, w_gate)
        u = torch.einsum("bsd,df->bsf", x, w_up)
        h = g * u
        return torch.einsum("bsf,fd->bsd", h, w_down)

    x = A_x
    xn = _layernorm(x, axis=-1)
    return x + _A_ref(xn, A_w_r, A_w_i) + _B_ref(xn, B_w_gate, B_w_up, B_w_down)
```

```asm
; @launch grid=(256,1,1) block=(512,1,1) lds=163840
.amdgcn_target "amdgcn-amd-amdhsa--gfx950"
.text
.globl parallel_sum__spectral_gfnet__glu_gated_bilinear__prompt_kernel
.p2align 8
.type parallel_sum__spectral_gfnet__glu_gated_bilinear__prompt_kernel,@function
parallel_sum__spectral_gfnet__glu_gated_bilinear__prompt_kernel:
    s_load_dwordx16 s[4:19], s[0:1], 0
    s_load_dwordx4 s[20:23], s[0:1], 64
    v_readfirstlane_b32 s52, v0
    v_and_b32 v1, 63, v0
    s_cmp_ge_u32 s2, 256
    s_cbranch_scc1 K_END
    v_lshlrev_b32 v1, 4, v1
    s_lshr_b32 s52, s52, 6
    s_and_b32 s52, s52, 7
    s_sub_u32 s66, s2, 32
    s_cbranch_scc0 G_WG
    s_getpc_b64 s[68:69]
PCREF:
    s_lshr_b32 s66, s2, 3
    s_lshl_b32 s66, s66, 7
    v_lshlrev_b32 v2, 9, v0
    v_add_u32 v2, s66, v2
    v_cmp_gt_u32 vcc, CODE_END-PCREF-4, v2
    s_cbranch_vccz T_WG
    v_min_u32 v2, CODE_END-PCREF-4, v2
    global_load_dword v255, v2, s[68:69]
    s_branch T_WG
G_WG:
    s_lshr_b32 s66, s66, 3
    s_and_b32 s54, s2, 6
    s_lshr_b32 s68, s54, 1
    s_lshl_b32 s54, s54, 1
    s_and_b32 s67, s66, 3
    s_add_u32 s54, s54, s67
    s_lshr_b32 s57, s66, 2
    s_and_b32 s67, s67, 3
    s_mul_i32 s67, s67, 1
    s_mul_i32 s68, s68, 1
    s_add_u32 s67, s67, s68
    s_mul_i32 s68, s57, 1
    s_add_u32 s67, s67, s68
    s_mul_i32 s68, s67, 37
    s_lshr_b32 s68, s68, 8
    s_mul_i32 s68, s68, 7
    s_sub_u32 s67, s67, s68
    s_lshl_b32 s67, s67, 2
    s_and_b32 s67, s67, 31
    s_mov_b32 s68, 0x06543210
    s_mov_b32 s69, 0x00654321
    s_lshr_b64 s[68:69], s[68:69], s67
    s_mov_b32 s58, s68
    s_and_b32 s56, s2, 1
    s_mul_i32 s55, s56, 7
    s_add_u32 s55, s55, s57
    s_and_b32 s53, s52, 3
    s_lshl_b32 s61, s54, 2
    s_add_u32 s61, s61, s53
    s_and_b32 s60, s61, 0x38
    s_and_b32 s67, s54, 1
    s_add_u32 s60, s60, s67
    s_lshl_b32 s67, s53, 1
    s_add_u32 s60, s60, s67
    s_lshl_b32 s64, s53, 11
    s_cmp_ge_u32 s52, 4
    s_cbranch_scc1 G_R1
    v_lshrrev_b32 v48, 7, v1
    v_mul_u32_u24 v224, 57344, v48
    v_lshrrev_b32 v48, 4, v1
    v_xor_b32 v48, v48, v1
    v_and_b32 v48, 0x70, v48
    v_add_u32 v224, v48, v224
    v_xor_b32 v225, 64, v224
    v_add_u32 v226, 915456, v224
    v_add_u32 v225, 457728, v225
    v_add_u32 v227, 915456, v225
    s_mul_i32 s73, s60, 896
    s_waitcnt lgkmcnt(0)
    s_mov_b64 s[24:25], s[4:5]
    s_mov_b32 s26, 0x1c0000
    s_mov_b32 s27, 0x20000
    s_lshl1_add_u32 m0, s64, 16384
    s_bfe_u32 s66, s58, 0x40000
    s_lshl_b32 s66, s66, 7
    s_add_u32 s72, s66, s73
    buffer_load_dwordx4 v224, s[24:27], s72 offen offset:0 lds
    buffer_load_dwordx4 v225, s[24:27], s72 offen offset:1024 lds
    buffer_load_dwordx4 v226, s[24:27], s72 offen offset:2048 lds
    buffer_load_dwordx4 v227, s[24:27], s72 offen offset:3072 lds
    s_lshl1_add_u32 m0, s64, 32768
    s_bfe_u32 s66, s58, 0x40004
    s_lshl_b32 s66, s66, 7
    s_add_u32 s72, s66, s73
    buffer_load_dwordx4 v224, s[24:27], s72 offen offset:0 lds
    buffer_load_dwordx4 v225, s[24:27], s72 offen offset:1024 lds
    buffer_load_dwordx4 v226, s[24:27], s72 offen offset:2048 lds
    buffer_load_dwordx4 v227, s[24:27], s72 offen offset:3072 lds
    s_add_u32 s6, s22, 0x430000
    s_addc_u32 s7, s23, 0
    s_load_dword s59, s[6:7], 8
    s_mov_b64 s[40:41], s[22:23]
    s_mov_b32 s42, 0xdd0000
    s_mov_b32 s43, 0x20000
    v_bfe_u32 v48, v1, 5, 4
    s_lshl_b32 s66, s55, 4
    v_add_u32 v48, s66, v48
    v_bfe_u32 v49, v1, 4, 1
    v_lshl_add_u32 v50, v48, 1, v49
    v_cmp_eq_u32 vcc, 1, v50
    v_mov_b32 v51, 224
    v_cvt_f32_u32 v49, v49
    v_cndmask_b32 v48, v48, v51, vcc
    v_mul_f32 v49, 0x3e800000, v49
    v_cvt_f32_u32 v48, v48
    v_cndmask_b32 v49, v49, 0, vcc
    v_mul_f32 v48, 0x3b124925, v48
    v_lshrrev_b32 v50, 9, v1
    v_lshlrev_b32 v50, 3, v50
    s_xor_b32 s67, s52, 0
    s_bfe_u32 s66, s58, 0x40000
    s_lshl_b32 s66, s66, 2
    s_add_u32 s66, s66, s67
    s_lshl_b32 s66, s66, 4
    s_sub_u32 s66, s66, 448
    v_add_u32 v50, s66, v50
    v_cvt_f32_i32 v50, v50
    v_fmac_f32 v49, v48, v50
    s_lshl_b32 s67, s67, 10
    s_add_u32 s67, s67, 131072
    v_add_u32 v51, s67, v1
    v_mov_b32 v50, 0
    s_mov_b32 s66, 0x3f803f80
    v_fmamk_f32 v57, v48, 0x3f800000, v49
    v_fmamk_f32 v58, v48, 0x40000000, v49
    v_fmamk_f32 v59, v48, 0x40400000, v49
    v_fmamk_f32 v60, v48, 0x40800000, v49
    v_fmamk_f32 v61, v48, 0x40a00000, v49
    v_fmamk_f32 v62, v48, 0x40c00000, v49
    v_fmamk_f32 v63, v48, 0x40e00000, v49
    v_cos_f32 v56, v49
    v_cos_f32 v57, v57
    v_cos_f32 v58, v58
    v_cos_f32 v59, v59
    v_cos_f32 v60, v60
    v_cos_f32 v61, v61
    v_cos_f32 v62, v62
    v_cos_f32 v63, v63
    v_cvt_pk_bf16_f32 v72, v56, v57
    v_cvt_pk_bf16_f32 v73, v58, v59
    v_cvt_pk_bf16_f32 v74, v60, v61
    v_cvt_pk_bf16_f32 v75, v62, v63
    ds_write_b128 v51, v[72:75] offset:0
    v_dot2c_f32_bf16 v50, s66, v72
    v_dot2c_f32_bf16 v50, s66, v73
    v_dot2c_f32_bf16 v50, s66, v74
    v_dot2c_f32_bf16 v50, s66, v75
    v_fmamk_f32 v64, v48, 0x43000000, v49
    v_fmamk_f32 v65, v48, 0x43010000, v49
    v_fmamk_f32 v66, v48, 0x43020000, v49
    v_fmamk_f32 v67, v48, 0x43030000, v49
    v_fmamk_f32 v68, v48, 0x43040000, v49
    v_fmamk_f32 v69, v48, 0x43050000, v49
    v_fmamk_f32 v70, v48, 0x43060000, v49
    v_fmamk_f32 v71, v48, 0x43070000, v49
    v_cos_f32 v64, v64
    v_cos_f32 v65, v65
    v_cos_f32 v66, v66
    v_cos_f32 v67, v67
    v_cos_f32 v68, v68
    v_cos_f32 v69, v69
    v_cos_f32 v70, v70
    v_cos_f32 v71, v71
    v_cvt_pk_bf16_f32 v76, v64, v65
    v_cvt_pk_bf16_f32 v77, v66, v67
    v_cvt_pk_bf16_f32 v78, v68, v69
    v_cvt_pk_bf16_f32 v79, v70, v71
    ds_write_b128 v51, v[76:79] offset:8192
    v_dot2c_f32_bf16 v50, s66, v76
    v_dot2c_f32_bf16 v50, s66, v77
    v_dot2c_f32_bf16 v50, s66, v78
    v_dot2c_f32_bf16 v50, s66, v79
    v_fmamk_f32 v56, v48, 0x43800000, v49
    v_fmamk_f32 v57, v48, 0x43808000, v49
    v_fmamk_f32 v58, v48, 0x43810000, v49
    v_fmamk_f32 v59, v48, 0x43818000, v49
    v_fmamk_f32 v60, v48, 0x43820000, v49
    v_fmamk_f32 v61, v48, 0x43828000, v49
    v_fmamk_f32 v62, v48, 0x43830000, v49
    v_fmamk_f32 v63, v48, 0x43838000, v49
    v_cos_f32 v56, v56
    v_cos_f32 v57, v57
    v_cos_f32 v58, v58
    v_cos_f32 v59, v59
    v_cos_f32 v60, v60
    v_cos_f32 v61, v61
    v_cos_f32 v62, v62
    v_cos_f32 v63, v63
    v_cvt_pk_bf16_f32 v72, v56, v57
    v_cvt_pk_bf16_f32 v73, v58, v59
    v_cvt_pk_bf16_f32 v74, v60, v61
    v_cvt_pk_bf16_f32 v75, v62, v63
    ds_write_b128 v51, v[72:75] offset:16384
    v_dot2c_f32_bf16 v50, s66, v72
    v_dot2c_f32_bf16 v50, s66, v73
    v_dot2c_f32_bf16 v50, s66, v74
    v_dot2c_f32_bf16 v50, s66, v75
    v_fmamk_f32 v64, v48, 0x43c00000, v49
    v_fmamk_f32 v65, v48, 0x43c08000, v49
    v_fmamk_f32 v66, v48, 0x43c10000, v49
    v_fmamk_f32 v67, v48, 0x43c18000, v49
    v_fmamk_f32 v68, v48, 0x43c20000, v49
    v_fmamk_f32 v69, v48, 0x43c28000, v49
    v_fmamk_f32 v70, v48, 0x43c30000, v49
    v_fmamk_f32 v71, v48, 0x43c38000, v49
    v_cos_f32 v64, v64
    v_cos_f32 v65, v65
    v_cos_f32 v66, v66
    v_cos_f32 v67, v67
    v_cos_f32 v68, v68
    v_cos_f32 v69, v69
    v_cos_f32 v70, v70
    v_cos_f32 v71, v71
    v_cvt_pk_bf16_f32 v76, v64, v65
    v_cvt_pk_bf16_f32 v77, v66, v67
    v_cvt_pk_bf16_f32 v78, v68, v69
    v_cvt_pk_bf16_f32 v79, v70, v71
    ds_write_b128 v51, v[76:79] offset:24576
    v_dot2c_f32_bf16 v50, s66, v76
    v_dot2c_f32_bf16 v50, s66, v77
    v_dot2c_f32_bf16 v50, s66, v78
    v_dot2c_f32_bf16 v50, s66, v79
    s_lshl_b32 s67, s52, 8
    s_add_u32 s67, s67, 159744
    v_lshrrev_b32 v51, 2, v1
    v_add_u32 v51, s67, v51
    ds_write_b32 v51, v50
    s_lshl1_add_u32 m0, s64, 49152
    s_bfe_u32 s66, s58, 0x40008
    s_lshl_b32 s66, s66, 7
    s_add_u32 s72, s66, s73
    buffer_load_dwordx4 v224, s[24:27], s72 offen offset:0 lds
    buffer_load_dwordx4 v225, s[24:27], s72 offen offset:1024 lds
    buffer_load_dwordx4 v226, s[24:27], s72 offen offset:2048 lds
    buffer_load_dwordx4 v227, s[24:27], s72 offen offset:3072 lds
    s_lshl1_add_u32 m0, s64, 65536
    s_bfe_u32 s66, s58, 0x4000c
    s_lshl_b32 s66, s66, 7
    s_add_u32 s72, s66, s73
    buffer_load_dwordx4 v224, s[24:27], s72 offen offset:0 lds
    buffer_load_dwordx4 v225, s[24:27], s72 offen offset:1024 lds
    buffer_load_dwordx4 v226, s[24:27], s72 offen offset:2048 lds
    buffer_load_dwordx4 v227, s[24:27], s72 offen offset:3072 lds
    v_bfe_u32 v48, v1, 4, 5
    v_bfe_u32 v49, v1, 5, 3
    v_lshrrev_b32 v50, 9, v1
    v_xor_b32 v49, v49, v50
    v_lshlrev_b32 v49, 4, v49
    v_lshl_add_u32 v10, v48, 7, v49
    s_lshl1_add_u32 s66, s64, 16384
    v_add_u32 v10, s66, v10
    v_xor_b32 v11, 32, v10
    v_xor_b32 v12, 64, v10
    v_xor_b32 v13, 96, v10
    v_lshrrev_b32 v48, 7, v1
    v_mul_u32_u24 v228, 3584, v48
    v_and_b32 v48, 2, v48
    v_bfe_u32 v49, v1, 5, 2
    v_xor_b32 v48, v48, v49
    v_lshl_add_u32 v228, v48, 5, v228
    v_and_b32 v48, 16, v1
    s_mul_i32 s66, s53, 57344
    s_lshl_b32 s67, s55, 7
    s_add_u32 s66, s66, s67
    v_add3_u32 v228, v228, v48, s66
    v_xor_b32 v229, 32, v228
    s_mov_b64 s[28:29], s[12:13]
    s_mov_b32 s30, 0x188000
    s_mov_b32 s31, 0x20000
    s_mov_b64 s[32:33], s[14:15]
    s_mov_b32 s34, 0x188000
    s_mov_b32 s35, 0x20000
    v_bfe_u32 v48, v1, 8, 1
    v_bfe_u32 v49, v1, 6, 2
    v_lshrrev_b32 v50, 9, v1
    v_lshl_add_u32 v51, v50, 3, v49
    v_lshlrev_b32 v51, 7, v51
    v_lshl_add_u32 v2, v48, 13, v51
    v_and_or_b32 v52, v49, 2, v48
    v_lshl_add_u32 v2, v52, 5, v2
    v_bfe_u32 v52, v1, 4, 2
    v_lshl_add_u32 v2, v52, 3, v2
    v_xor_b32 v3, 32, v2
    v_xor_b32 v4, 64, v2
    v_xor_b32 v5, 96, v2
    v_add_u32 v6, 65536, v2
    v_add_u32 v7, 65536, v3
    v_add_u32 v8, 65536, v4
    v_add_u32 v9, 65536, v5
    v_bfe_u32 v15, v1, 4, 5
    s_lshl_b32 s66, s53, 7
    s_add_u32 s66, s66, 161792
    v_lshl_add_u32 v15, v15, 2, s66
    s_lshl_b32 s3, s61, 4
    s_add_u32 s3, s3, s55
    s_lshl_b32 s3, s3, 7
    s_add_u32 s3, s3, 4456448
    s_waitcnt lgkmcnt(0)
    s_or_b32 s59, s59, 0x40004000
    s_add_u32 s59, s59, 1
    s_and_b32 s59, s59, 0xbfffbfff
    v_mov_b32 v14, s59
    s_mov_b32 s63, 0
    v_mov_b32 v80, 0x3f803f80
    v_mov_b32 v81, 0x3f803f80
    s_mov_b32 s74, 0x22222222
    s_mov_b32 s75, 0x22222222
    s_mov_b32 s76, 0x44444444
    s_mov_b32 s77, 0x44444444
    s_mov_b32 s78, 0x88888888
    s_mov_b32 s79, 0x88888888
    s_waitcnt vmcnt(12)
    ds_read_b128 v[112:115], v10 offset:0
    ds_read_b128 v[116:119], v11 offset:0
    ds_read_b128 v[120:123], v12 offset:0
    ds_read_b128 v[124:127], v13 offset:0
    s_lshl1_add_u32 m0, s64, 81920
    s_bfe_u32 s66, s58, 0x40010
    s_lshl_b32 s66, s66, 7
    s_add_u32 s72, s66, s73
    buffer_load_dwordx4 v224, s[24:27], s72 offen offset:0 lds
    buffer_load_dwordx4 v225, s[24:27], s72 offen offset:1024 lds
    buffer_load_dwordx4 v226, s[24:27], s72 offen offset:2048 lds
    buffer_load_dwordx4 v227, s[24:27], s72 offen offset:3072 lds
    s_add_u32 s67, s54, 0
    s_and_b32 s67, s67, 3
    s_and_b32 s68, s54, 3
    s_mul_i32 s67, s67, 6
    s_mul_i32 s68, s68, 6
    s_bfe_u32 s66, s58, 0x40000
    s_add_u32 s67, s67, s66
    s_add_u32 s67, s67, s68
    s_mul_i32 s68, s67, 37
    s_lshr_b32 s68, s68, 8
    s_mul_i32 s68, s68, 7
    s_sub_u32 s67, s67, s68
    s_lshl_b32 s67, s67, 2
    s_mov_b32 s68, 0x06543210
    s_mov_b32 s69, 0x00654321
    s_lshr_b64 s[68:69], s[68:69], s67
    s_mov_b32 s10, s68
    s_lshl1_add_u32 s11, s54, s56
    s_mul_i32 s62, s11, 229376
    s_add_u32 s62, s62, 5242880
    s_lshl_b32 s8, s11, 12
    s_add_u32 s8, s8, 4456448
    s_lshl_b32 s11, s11, 11
    s_add_u32 s11, s11, 12582912
    s_mul_i32 s51, s61, 28
    s_add_u32 s51, s51, s55
    s_lshl_b32 s51, s51, 12
    s_add_u32 s51, s51, 5242880
    s_mul_i32 s65, s53, 7
    s_bfe_u32 s66, s10, 0x40000
    s_lshl1_add_u32 s66, s66, s53
    s_lshr_b32 s69, s53, 1
    s_lshl_b32 s6, s69, 24
    s_mov_b32 s7, 0x010101
    s_mul_i32 s69, s69, 14
    s_add_u32 s67, s66, 0
    s_sub_u32 s68, s67, 14
    s_cselect_b32 s67, s67, s68
    s_lshl_b32 s67, s67, 1
    s_or_b32 s6, s6, s67
    s_add_u32 s67, s66, 4
    s_sub_u32 s68, s67, 14
    s_cselect_b32 s67, s67, s68
    s_lshl_b32 s67, s67, 9
    s_or_b32 s6, s6, s67
    s_add_u32 s67, s66, 8
    s_sub_u32 s68, s67, 14
    s_cselect_b32 s67, s67, s68
    s_lshl_b32 s67, s67, 17
    s_or_b32 s6, s6, s67
    s_add_u32 s67, s66, 12
    s_sub_u32 s67, s67, s69
    s_sub_u32 s68, s67, 14
    s_cselect_b32 s67, s67, s68
    s_lshl_b32 s67, s67, 25
    s_or_b32 s6, s6, s67
    s_add_u32 s67, s66, 2
    s_sub_u32 s68, s67, 14
    s_cselect_b32 s67, s67, s68
    s_lshl_b32 s67, s67, 1
    s_or_b32 s7, s7, s67
    s_add_u32 s67, s66, 6
    s_sub_u32 s68, s67, 14
    s_cselect_b32 s67, s67, s68
    s_lshl_b32 s67, s67, 9
    s_or_b32 s7, s7, s67
    s_add_u32 s67, s66, 10
    s_sub_u32 s68, s67, 14
    s_cselect_b32 s67, s67, s68
    s_lshl_b32 s67, s67, 17
    s_or_b32 s7, s7, s67
    s_waitcnt vmcnt(12) lgkmcnt(0)
    s_barrier
    ds_read_b128 v[128:131], v10 offset:16384
    ds_read_b128 v[132:135], v11 offset:16384
    ds_read_b128 v[136:139], v12 offset:16384
    ds_read_b128 v[140:143], v13 offset:16384
    s_lshl1_add_u32 m0, s64, 98304
    s_bfe_u32 s66, s58, 0x40014
    s_lshl_b32 s66, s66, 7
    s_add_u32 s72, s66, s73
    buffer_load_dwordx4 v224, s[24:27], s72 offen offset:0 lds
    buffer_load_dwordx4 v225, s[24:27], s72 offen offset:1024 lds
    buffer_load_dwordx4 v226, s[24:27], s72 offen offset:2048 lds
    buffer_load_dwordx4 v227, s[24:27], s72 offen offset:3072 lds
    v_bfe_u32 v48, v1, 8, 1
    v_bfe_u32 v49, v1, 6, 2
    v_lshrrev_b32 v50, 9, v1
    v_lshl_add_u32 v234, v50, 2, v49
    v_lshlrev_b32 v234, 7, v234
    v_bfe_u32 v51, v1, 7, 1
    v_lshl_add_u32 v234, v51, 6, v234
    v_lshl_add_u32 v234, v48, 5, v234
    v_bfe_u32 v51, v1, 4, 2
    v_lshl_add_u32 v234, v51, 3, v234
    s_lshl1_add_u32 s66, s64, 0
    v_add_u32 v234, s66, v234
    v_xor_b32 v235, 64, v234
    v_lshrrev_b32 v49, 7, v1
    v_mul_u32_u24 v230, 896, v49
    v_lshlrev_b32 v48, 6, v48
    v_and_b32 v51, 0x70, v1
    v_xor_b32 v48, v48, v51
    s_lshl_b32 s67, s57, 7
    v_add3_u32 v230, v230, v48, s67
    s_mov_b64 s[36:37], s[16:17]
    s_mov_b32 s38, 0x188000
    s_mov_b32 s39, 0x20000
    v_mfma_f32_4x4x4_16b_bf16 v[64:67], v[112:113], v[112:113], 0
    v_mfma_f32_4x4x4_16b_bf16 v[72:75], v[80:81], v[112:113], 0
    v_mfma_f32_4x4x4_16b_bf16 v[68:71], v[114:115], v[114:115], 0
    v_mfma_f32_4x4x4_16b_bf16 v[76:79], v[80:81], v[114:115], 0
    v_mfma_f32_4x4x4_16b_bf16 v[64:67], v[116:117], v[116:117], v[64:67]
    v_mfma_f32_4x4x4_16b_bf16 v[72:75], v[80:81], v[116:117], v[72:75]
    v_mfma_f32_4x4x4_16b_bf16 v[68:71], v[118:119], v[118:119], v[68:71]
    v_mfma_f32_4x4x4_16b_bf16 v[76:79], v[80:81], v[118:119], v[76:79]
    v_mfma_f32_4x4x4_16b_bf16 v[64:67], v[120:121], v[120:121], v[64:67]
    v_mfma_f32_4x4x4_16b_bf16 v[72:75], v[80:81], v[120:121], v[72:75]
    v_mfma_f32_4x4x4_16b_bf16 v[68:71], v[122:123], v[122:123], v[68:71]
    v_mfma_f32_4x4x4_16b_bf16 v[76:79], v[80:81], v[122:123], v[76:79]
    v_mfma_f32_4x4x4_16b_bf16 v[64:67], v[124:125], v[124:125], v[64:67]
    v_mfma_f32_4x4x4_16b_bf16 v[72:75], v[80:81], v[124:125], v[72:75]
    v_mfma_f32_4x4x4_16b_bf16 v[68:71], v[126:127], v[126:127], v[68:71]
    v_mfma_f32_4x4x4_16b_bf16 v[76:79], v[80:81], v[126:127], v[76:79]
    s_waitcnt vmcnt(12)
    ds_read_b128 v[144:147], v10 offset:32768
    ds_read_b128 v[148:151], v11 offset:32768
    ds_read_b128 v[152:155], v12 offset:32768
    ds_read_b128 v[156:159], v13 offset:32768
    s_lshl1_add_u32 m0, s64, 114688
    s_bfe_u32 s66, s58, 0x40018
    s_lshl_b32 s66, s66, 7
    s_add_u32 s72, s66, s73
    buffer_load_dwordx4 v224, s[24:27], s72 offen offset:0 lds
    buffer_load_dwordx4 v225, s[24:27], s72 offen offset:1024 lds
    buffer_load_dwordx4 v226, s[24:27], s72 offen offset:2048 lds
    buffer_load_dwordx4 v227, s[24:27], s72 offen offset:3072 lds
    v_add_u32 v236, 65536, v234
    v_add_u32 v238, 131072, v234
    v_add_u32 v237, 65536, v235
    v_add_u32 v239, 131072, v235
    s_waitcnt lgkmcnt(7)
    v_mfma_f32_4x4x4_16b_bf16 v[64:67], v[128:129], v[128:129], v[64:67]
    v_mfma_f32_4x4x4_16b_bf16 v[72:75], v[80:81], v[128:129], v[72:75]
    v_mfma_f32_4x4x4_16b_bf16 v[68:71], v[130:131], v[130:131], v[68:71]
    v_mfma_f32_4x4x4_16b_bf16 v[76:79], v[80:81], v[130:131], v[76:79]
    s_waitcnt lgkmcnt(6)
    v_mfma_f32_4x4x4_16b_bf16 v[64:67], v[132:133], v[132:133], v[64:67]
    v_mfma_f32_4x4x4_16b_bf16 v[72:75], v[80:81], v[132:133], v[72:75]
    v_mfma_f32_4x4x4_16b_bf16 v[68:71], v[134:135], v[134:135], v[68:71]
    v_mfma_f32_4x4x4_16b_bf16 v[76:79], v[80:81], v[134:135], v[76:79]
    s_waitcnt lgkmcnt(5)
    v_mfma_f32_4x4x4_16b_bf16 v[64:67], v[136:137], v[136:137], v[64:67]
    v_mfma_f32_4x4x4_16b_bf16 v[72:75], v[80:81], v[136:137], v[72:75]
    v_mfma_f32_4x4x4_16b_bf16 v[68:71], v[138:139], v[138:139], v[68:71]
    v_mfma_f32_4x4x4_16b_bf16 v[76:79], v[80:81], v[138:139], v[76:79]
    s_waitcnt lgkmcnt(4)
    v_mfma_f32_4x4x4_16b_bf16 v[64:67], v[140:141], v[140:141], v[64:67]
    v_mfma_f32_4x4x4_16b_bf16 v[72:75], v[80:81], v[140:141], v[72:75]
    v_mfma_f32_4x4x4_16b_bf16 v[68:71], v[142:143], v[142:143], v[68:71]
    v_mfma_f32_4x4x4_16b_bf16 v[76:79], v[80:81], v[142:143], v[76:79]
    s_waitcnt vmcnt(12) lgkmcnt(0)
    s_barrier
    ds_read_b128 v[160:163], v10 offset:49152
    ds_read_b128 v[164:167], v11 offset:49152
    ds_read_b128 v[168:171], v12 offset:49152
    ds_read_b128 v[172:175], v13 offset:49152
    s_bfe_u32 s70, s58, 0x40000
    s_mul_i32 s70, s70, 229376
    s_add_u32 s71, s70, 27648
    s_add_u32 m0, s64, 0
    s_nop 0
    buffer_load_dwordx4 v228, s[28:31], s70 offen offset:0 lds
    buffer_load_dwordx4 v228, s[28:31], s71 offen offset:1024 lds
    s_add_u32 m0, s64, 8192
    s_nop 0
    buffer_load_dwordx4 v229, s[32:35], s70 offen offset:0 lds
    buffer_load_dwordx4 v229, s[32:35], s71 offen offset:1024 lds
    v_mfma_f32_4x4x4_16b_bf16 v[64:67], v[144:145], v[144:145], v[64:67]
    v_mfma_f32_4x4x4_16b_bf16 v[72:75], v[80:81], v[144:145], v[72:75]
    v_mfma_f32_4x4x4_16b_bf16 v[68:71], v[146:147], v[146:147], v[68:71]
    v_mfma_f32_4x4x4_16b_bf16 v[76:79], v[80:81], v[146:147], v[76:79]
    v_mfma_f32_4x4x4_16b_bf16 v[64:67], v[148:149], v[148:149], v[64:67]
    v_mfma_f32_4x4x4_16b_bf16 v[72:75], v[80:81], v[148:149], v[72:75]
    v_mfma_f32_4x4x4_16b_bf16 v[68:71], v[150:151], v[150:151], v[68:71]
    v_mfma_f32_4x4x4_16b_bf16 v[76:79], v[80:81], v[150:151], v[76:79]
    v_mfma_f32_4x4x4_16b_bf16 v[64:67], v[152:153], v[152:153], v[64:67]
    v_mfma_f32_4x4x4_16b_bf16 v[72:75], v[80:81], v[152:153], v[72:75]
    v_mfma_f32_4x4x4_16b_bf16 v[68:71], v[154:155], v[154:155], v[68:71]
    v_mfma_f32_4x4x4_16b_bf16 v[76:79], v[80:81], v[154:155], v[76:79]
    v_mfma_f32_4x4x4_16b_bf16 v[64:67], v[156:157], v[156:157], v[64:67]
    v_mfma_f32_4x4x4_16b_bf16 v[72:75], v[80:81], v[156:157], v[72:75]
    v_mfma_f32_4x4x4_16b_bf16 v[68:71], v[158:159], v[158:159], v[68:71]
    v_mfma_f32_4x4x4_16b_bf16 v[76:79], v[80:81], v[158:159], v[76:79]
    s_waitcnt vmcnt(12)
    v_add_u32 v10, 65536, v10
    v_add_u32 v11, 65536, v11
    v_add_u32 v12, 65536, v12
    v_add_u32 v13, 65536, v13
    ds_read_b128 v[176:179], v10 offset:0
    ds_read_b128 v[180:183], v11 offset:0
    ds_read_b128 v[184:187], v12 offset:0
    ds_read_b128 v[188:191], v13 offset:0
    s_bfe_u32 s70, s58, 0x40004
    s_mul_i32 s70, s70, 229376
    s_add_u32 s71, s70, 27648
    s_add_u32 m0, s64, 16384
    s_nop 0
    buffer_load_dwordx4 v228, s[28:31], s70 offen offset:0 lds
    buffer_load_dwordx4 v228, s[28:31], s71 offen offset:1024 lds
    s_add_u32 m0, s64, 24576
    s_nop 0
    buffer_load_dwordx4 v229, s[32:35], s70 offen offset:0 lds
    buffer_load_dwordx4 v229, s[32:35], s71 offen offset:1024 lds
    s_waitcnt lgkmcnt(7)
    v_mfma_f32_4x4x4_16b_bf16 v[64:67], v[160:161], v[160:161], v[64:67]
    v_mfma_f32_4x4x4_16b_bf16 v[72:75], v[80:81], v[160:161], v[72:75]
    v_mfma_f32_4x4x4_16b_bf16 v[68:71], v[162:163], v[162:163], v[68:71]
    v_mfma_f32_4x4x4_16b_bf16 v[76:79], v[80:81], v[162:163], v[76:79]
    s_waitcnt lgkmcnt(6)
    v_mfma_f32_4x4x4_16b_bf16 v[64:67], v[164:165], v[164:165], v[64:67]
    v_mfma_f32_4x4x4_16b_bf16 v[72:75], v[80:81], v[164:165], v[72:75]
    v_mfma_f32_4x4x4_16b_bf16 v[68:71], v[166:167], v[166:167], v[68:71]
    v_mfma_f32_4x4x4_16b_bf16 v[76:79], v[80:81], v[166:167], v[76:79]
    s_waitcnt lgkmcnt(5)
    v_mfma_f32_4x4x4_16b_bf16 v[64:67], v[168:169], v[168:169], v[64:67]
    v_mfma_f32_4x4x4_16b_bf16 v[72:75], v[80:81], v[168:169], v[72:75]
    v_mfma_f32_4x4x4_16b_bf16 v[68:71], v[170:171], v[170:171], v[68:71]
    v_mfma_f32_4x4x4_16b_bf16 v[76:79], v[80:81], v[170:171], v[76:79]
    s_waitcnt lgkmcnt(4)
    v_mfma_f32_4x4x4_16b_bf16 v[64:67], v[172:173], v[172:173], v[64:67]
    v_mfma_f32_4x4x4_16b_bf16 v[72:75], v[80:81], v[172:173], v[72:75]
    v_mfma_f32_4x4x4_16b_bf16 v[68:71], v[174:175], v[174:175], v[68:71]
    v_mfma_f32_4x4x4_16b_bf16 v[76:79], v[80:81], v[174:175], v[76:79]
    s_waitcnt vmcnt(12) lgkmcnt(0)
    s_barrier
    ds_read_b128 v[192:195], v10 offset:16384
    ds_read_b128 v[196:199], v11 offset:16384
    ds_read_b128 v[200:203], v12 offset:16384
    ds_read_b128 v[204:207], v13 offset:16384
    v_mfma_f32_4x4x4_16b_bf16 v[64:67], v[176:177], v[176:177], v[64:67]
    v_mfma_f32_4x4x4_16b_bf16 v[72:75], v[80:81], v[176:177], v[72:75]
    v_mfma_f32_4x4x4_16b_bf16 v[68:71], v[178:179], v[178:179], v[68:71]
    v_mfma_f32_4x4x4_16b_bf16 v[76:79], v[80:81], v[178:179], v[76:79]
    v_mfma_f32_4x4x4_16b_bf16 v[64:67], v[180:181], v[180:181], v[64:67]
    v_mfma_f32_4x4x4_16b_bf16 v[72:75], v[80:81], v[180:181], v[72:75]
    v_mfma_f32_4x4x4_16b_bf16 v[68:71], v[182:183], v[182:183], v[68:71]
    v_mfma_f32_4x4x4_16b_bf16 v[76:79], v[80:81], v[182:183], v[76:79]
    v_mfma_f32_4x4x4_16b_bf16 v[64:67], v[184:185], v[184:185], v[64:67]
    v_mfma_f32_4x4x4_16b_bf16 v[72:75], v[80:81], v[184:185], v[72:75]
    v_mfma_f32_4x4x4_16b_bf16 v[68:71], v[186:187], v[186:187], v[68:71]
    v_mfma_f32_4x4x4_16b_bf16 v[76:79], v[80:81], v[186:187], v[76:79]
    v_mfma_f32_4x4x4_16b_bf16 v[64:67], v[188:189], v[188:189], v[64:67]
    v_mfma_f32_4x4x4_16b_bf16 v[72:75], v[80:81], v[188:189], v[72:75]
    v_mfma_f32_4x4x4_16b_bf16 v[68:71], v[190:191], v[190:191], v[68:71]
    v_mfma_f32_4x4x4_16b_bf16 v[76:79], v[80:81], v[190:191], v[76:79]
    s_waitcnt vmcnt(8) lgkmcnt(0)
    s_barrier
    s_setprio 1
    ds_read_b128 v[208:211], v10 offset:32768
    ds_read_b128 v[212:215], v11 offset:32768
    ds_read_b128 v[216:219], v12 offset:32768
    ds_read_b128 v[220:223], v13 offset:32768
    v_mfma_f32_4x4x4_16b_bf16 v[64:67], v[192:193], v[192:193], v[64:67]
    v_mfma_f32_4x4x4_16b_bf16 v[72:75], v[80:81], v[192:193], v[72:75]
    v_mfma_f32_4x4x4_16b_bf16 v[68:71], v[194:195], v[194:195], v[68:71]
    v_mfma_f32_4x4x4_16b_bf16 v[76:79], v[80:81], v[194:195], v[76:79]
    v_mfma_f32_4x4x4_16b_bf16 v[64:67], v[196:197], v[196:197], v[64:67]
    v_mfma_f32_4x4x4_16b_bf16 v[72:75], v[80:81], v[196:197], v[72:75]
    v_mfma_f32_4x4x4_16b_bf16 v[68:71], v[198:199], v[198:199], v[68:71]
    v_mfma_f32_4x4x4_16b_bf16 v[76:79], v[80:81], v[198:199], v[76:79]
    v_mfma_f32_4x4x4_16b_bf16 v[64:67], v[200:201], v[200:201], v[64:67]
    v_mfma_f32_4x4x4_16b_bf16 v[72:75], v[80:81], v[200:201], v[72:75]
    v_mfma_f32_4x4x4_16b_bf16 v[68:71], v[202:203], v[202:203], v[68:71]
    v_mfma_f32_4x4x4_16b_bf16 v[76:79], v[80:81], v[202:203], v[76:79]
    v_mfma_f32_4x4x4_16b_bf16 v[64:67], v[204:205], v[204:205], v[64:67]
    v_mfma_f32_4x4x4_16b_bf16 v[72:75], v[80:81], v[204:205], v[72:75]
    v_mfma_f32_4x4x4_16b_bf16 v[68:71], v[206:207], v[206:207], v[68:71]
    v_mfma_f32_4x4x4_16b_bf16 v[76:79], v[80:81], v[206:207], v[76:79]
    s_waitcnt lgkmcnt(3)
    v_mfma_f32_4x4x4_16b_bf16 v[64:67], v[208:209], v[208:209], v[64:67]
    v_mfma_f32_4x4x4_16b_bf16 v[72:75], v[80:81], v[208:209], v[72:75]
    v_mfma_f32_4x4x4_16b_bf16 v[68:71], v[210:211], v[210:211], v[68:71]
    v_mfma_f32_4x4x4_16b_bf16 v[76:79], v[80:81], v[210:211], v[76:79]
    s_waitcnt lgkmcnt(2)
    v_mfma_f32_4x4x4_16b_bf16 v[64:67], v[212:213], v[212:213], v[64:67]
    v_mfma_f32_4x4x4_16b_bf16 v[72:75], v[80:81], v[212:213], v[72:75]
    v_mfma_f32_4x4x4_16b_bf16 v[68:71], v[214:215], v[214:215], v[68:71]
    v_mfma_f32_4x4x4_16b_bf16 v[76:79], v[80:81], v[214:215], v[76:79]
    s_waitcnt lgkmcnt(1)
    v_mfma_f32_4x4x4_16b_bf16 v[64:67], v[216:217], v[216:217], v[64:67]
    v_mfma_f32_4x4x4_16b_bf16 v[72:75], v[80:81], v[216:217], v[72:75]
    v_mfma_f32_4x4x4_16b_bf16 v[68:71], v[218:219], v[218:219], v[68:71]
    v_mfma_f32_4x4x4_16b_bf16 v[76:79], v[80:81], v[218:219], v[76:79]
    s_waitcnt lgkmcnt(0)
    v_mfma_f32_4x4x4_16b_bf16 v[64:67], v[220:221], v[220:221], v[64:67]
    v_mfma_f32_4x4x4_16b_bf16 v[72:75], v[80:81], v[220:221], v[72:75]
    v_mfma_f32_4x4x4_16b_bf16 v[68:71], v[222:223], v[222:223], v[68:71]
    v_mfma_f32_4x4x4_16b_bf16 v[76:79], v[80:81], v[222:223], v[76:79]
    s_nop 3
    v_add_f32 v64, v64, v68
    v_add_f32 v65, v65, v69
    v_add_f32 v66, v66, v70
    v_add_f32 v67, v67, v71
    v_add_f32 v72, v72, v76
    v_cndmask_b32 v64, v64, v65, s[74:75]
    v_mov_b32 v73, v72
    v_cndmask_b32 v64, v64, v66, s[76:77]
    v_cndmask_b32 v64, v64, v67, s[78:79]
    v_permlane32_swap_b32 v72, v73
    v_mov_b32 v65, v64
    v_add_f32 v72, v72, v73
    v_mul_f32 v72, 0x3b124925, v72
    v_permlane32_swap_b32 v64, v65
    v_cvt_pk_bf16_f32 v82, -v72, -v72
    v_add_f32 v64, v64, v65
    v_mul_f32 v64, 0x3b124925, v64
    ds_write_b32 v15, v82
    v_fma_f32 v64, -v72, v72, v64
    v_max_f32 v64, 0, v64
    v_cvt_pk_bf16_f32 v64, v64, v64
    v_and_b32 v64, 0xffff0000, v64
    v_add_f32 v64, 0x3727c5ac, v64
    v_cvt_pk_bf16_f32 v64, v64, v64
    v_and_b32 v64, 0xffff0000, v64
    v_sqrt_f32 v64, v64
    v_and_b32 v72, 0xffff0000, v82
    v_cvt_pk_bf16_f32 v64, v64, v64
    v_and_b32 v64, 0xffff0000, v64
    v_rcp_f32 v231, v64
    s_nop 0
    ds_write_b32 v15, v231 offset:512
    v_mul_f32 v232, v72, v231
    v_lshlrev_b32 v240, 16, v112
    v_and_b32 v241, 0xffff0000, v112
    v_lshlrev_b32 v242, 16, v113
    v_and_b32 v243, 0xffff0000, v113
    v_fma_f32 v240, v240, v231, v232
    v_fma_f32 v241, v241, v231, v232
    v_fma_f32 v242, v242, v231, v232
    v_fma_f32 v243, v243, v231, v232
    v_cvt_pk_bf16_f32 v112, v240, v241
    v_cvt_pk_bf16_f32 v113, v242, v243
    v_lshlrev_b32 v244, 16, v114
    v_and_b32 v245, 0xffff0000, v114
    v_lshlrev_b32 v246, 16, v115
    v_and_b32 v247, 0xffff0000, v115
    v_fma_f32 v244, v244, v231, v232
    v_fma_f32 v245, v245, v231, v232
    v_fma_f32 v246, v246, v231, v232
    v_fma_f32 v247, v247, v231, v232
    v_cvt_pk_bf16_f32 v114, v244, v245
    v_cvt_pk_bf16_f32 v115, v246, v247
    s_waitcnt vmcnt(0)
    s_waitcnt lgkmcnt(0)
    s_barrier
    ds_read_b64_tr_b16 v[16:17], v2 offset:0
    ds_read_b64_tr_b16 v[18:19], v2 offset:512
    ds_read_b64_tr_b16 v[20:21], v3 offset:0
    ds_read_b64_tr_b16 v[22:23], v3 offset:512
    ds_read_b64_tr_b16 v[24:25], v4 offset:0
    ds_read_b64_tr_b16 v[26:27], v4 offset:512
    ds_read_b64_tr_b16 v[28:29], v5 offset:0
    ds_read_b64_tr_b16 v[30:31], v5 offset:512
    ds_read_b64_tr_b16 v[32:33], v2 offset:2048
    ds_read_b64_tr_b16 v[34:35], v2 offset:2560
    ds_read_b64_tr_b16 v[36:37], v3 offset:2048
    ds_read_b64_tr_b16 v[38:39], v3 offset:2560
    v_lshlrev_b32 v240, 16, v116
    v_and_b32 v241, 0xffff0000, v116
    v_lshlrev_b32 v242, 16, v117
    v_and_b32 v243, 0xffff0000, v117
    v_fma_f32 v240, v240, v231, v232
    v_fma_f32 v241, v241, v231, v232
    v_fma_f32 v242, v242, v231, v232
    v_fma_f32 v243, v243, v231, v232
    v_cvt_pk_bf16_f32 v116, v240, v241
    v_cvt_pk_bf16_f32 v117, v242, v243
    v_lshlrev_b32 v244, 16, v118
    v_and_b32 v245, 0xffff0000, v118
    v_lshlrev_b32 v246, 16, v119
    v_and_b32 v247, 0xffff0000, v119
    v_fma_f32 v244, v244, v231, v232
    v_fma_f32 v245, v245, v231, v232
    v_fma_f32 v246, v246, v231, v232
    v_fma_f32 v247, v247, v231, v232
    v_cvt_pk_bf16_f32 v118, v244, v245
    v_cvt_pk_bf16_f32 v119, v246, v247
    s_waitcnt lgkmcnt(10)
    v_mfma_f32_32x32x16_bf16 v[48:63], v[16:19], v[112:115], 0
    ds_read_b64_tr_b16 v[40:41], v4 offset:2048
    ds_read_b64_tr_b16 v[42:43], v4 offset:2560
    v_lshlrev_b32 v240, 16, v120
    v_and_b32 v241, 0xffff0000, v120
    v_lshlrev_b32 v242, 16, v121
    v_and_b32 v243, 0xffff0000, v121
    v_fma_f32 v240, v240, v231, v232
    v_fma_f32 v241, v241, v231, v232
    s_waitcnt lgkmcnt(10)
    v_mfma_f32_32x32x16_bf16 v[64:79], v[20:23], v[112:115], 0
    ds_read_b64_tr_b16 v[44:45], v5 offset:2048
    ds_read_b64_tr_b16 v[46:47], v5 offset:2560
    v_fma_f32 v242, v242, v231, v232
    v_fma_f32 v243, v243, v231, v232
    v_cvt_pk_bf16_f32 v120, v240, v241
    v_cvt_pk_bf16_f32 v121, v242, v243
    v_lshlrev_b32 v244, 16, v122
    v_and_b32 v245, 0xffff0000, v122
    s_waitcnt lgkmcnt(10)
    v_mfma_f32_32x32x16_bf16 v[80:95], v[24:27], v[112:115], 0
    ds_read_b64_tr_b16 v[16:17], v2 offset:4096
    ds_read_b64_tr_b16 v[18:19], v2 offset:4608
    v_lshlrev_b32 v246, 16, v123
    v_and_b32 v247, 0xffff0000, v123
    v_fma_f32 v244, v244, v231, v232
    v_fma_f32 v245, v245, v231, v232
    v_fma_f32 v246, v246, v231, v232
    v_fma_f32 v247, v247, v231, v232
    s_waitcnt lgkmcnt(10)
    v_mfma_f32_32x32x16_bf16 v[96:111], v[28:31], v[112:115], 0
    ds_read_b64_tr_b16 v[20:21], v3 offset:4096
    ds_read_b64_tr_b16 v[22:23], v3 offset:4608
    v_cvt_pk_bf16_f32 v122, v244, v245
    v_cvt_pk_bf16_f32 v123, v246, v247
    v_lshlrev_b32 v240, 16, v124
    v_and_b32 v241, 0xffff0000, v124
    v_lshlrev_b32 v242, 16, v125
    v_and_b32 v243, 0xffff0000, v125
    s_waitcnt lgkmcnt(10)
    v_mfma_f32_32x32x16_bf16 v[48:63], v[32:35], v[116:119], v[48:63]
    ds_read_b64_tr_b16 v[24:25], v4 offset:4096
    ds_read_b64_tr_b16 v[26:27], v4 offset:4608
    v_fma_f32 v240, v240, v231, v232
    v_fma_f32 v241, v241, v231, v232
    v_fma_f32 v242, v242, v231, v232
    v_fma_f32 v243, v243, v231, v232
    v_cvt_pk_bf16_f32 v124, v240, v241
    v_cvt_pk_bf16_f32 v125, v242, v243
    s_waitcnt lgkmcnt(10)
    v_mfma_f32_32x32x16_bf16 v[64:79], v[36:39], v[116:119], v[64:79]
    ds_read_b64_tr_b16 v[28:29], v5 offset:4096
    ds_read_b64_tr_b16 v[30:31], v5 offset:4608
    v_lshlrev_b32 v244, 16, v126
    v_and_b32 v245, 0xffff0000, v126
    v_lshlrev_b32 v246, 16, v127
    v_and_b32 v247, 0xffff0000, v127
    v_fma_f32 v244, v244, v231, v232
    v_fma_f32 v245, v245, v231, v232
    s_waitcnt lgkmcnt(10)
    v_mfma_f32_32x32x16_bf16 v[80:95], v[40:43], v[116:119], v[80:95]
    ds_read_b64_tr_b16 v[32:33], v2 offset:6144
    ds_read_b64_tr_b16 v[34:35], v2 offset:6656
    v_fma_f32 v246, v246, v231, v232
    v_fma_f32 v247, v247, v231, v232
    v_cvt_pk_bf16_f32 v126, v244, v245
    v_cvt_pk_bf16_f32 v127, v246, v247
    v_lshlrev_b32 v240, 16, v128
    v_and_b32 v241, 0xffff0000, v128
    s_waitcnt lgkmcnt(10)
    v_mfma_f32_32x32x16_bf16 v[96:111], v[44:47], v[116:119], v[96:111]
    ds_read_b64_tr_b16 v[36:37], v3 offset:6144
    ds_read_b64_tr_b16 v[38:39], v3 offset:6656
    v_lshlrev_b32 v242, 16, v129
    v_and_b32 v243, 0xffff0000, v129
    v_fma_f32 v240, v240, v231, v232
    v_fma_f32 v241, v241, v231, v232
    v_fma_f32 v242, v242, v231, v232
    v_fma_f32 v243, v243, v231, v232
    s_waitcnt lgkmcnt(10)
    v_mfma_f32_32x32x16_bf16 v[48:63], v[16:19], v[120:123], v[48:63]
    ds_read_b64_tr_b16 v[40:41], v4 offset:6144
    ds_read_b64_tr_b16 v[42:43], v4 offset:6656
    v_cvt_pk_bf16_f32 v128, v240, v241
    v_cvt_pk_bf16_f32 v129, v242, v243
    v_lshlrev_b32 v244, 16, v130
    v_and_b32 v245, 0xffff0000, v130
    v_lshlrev_b32 v246, 16, v131
    v_and_b32 v247, 0xffff0000, v131
    s_waitcnt lgkmcnt(10)
    v_mfma_f32_32x32x16_bf16 v[64:79], v[20:23], v[120:123], v[64:79]
    ds_read_b64_tr_b16 v[44:45], v5 offset:6144
    ds_read_b64_tr_b16 v[46:47], v5 offset:6656
    v_fma_f32 v244, v244, v231, v232
    v_fma_f32 v245, v245, v231, v232
    v_fma_f32 v246, v246, v231, v232
    v_fma_f32 v247, v247, v231, v232
    v_cvt_pk_bf16_f32 v130, v244, v245
    v_cvt_pk_bf16_f32 v131, v246, v247
    s_waitcnt lgkmcnt(10)
    v_mfma_f32_32x32x16_bf16 v[80:95], v[24:27], v[120:123], v[80:95]
    ds_read_b64_tr_b16 v[16:17], v2 offset:16384
    ds_read_b64_tr_b16 v[18:19], v2 offset:16896
    v_lshlrev_b32 v240, 16, v132
    v_and_b32 v241, 0xffff0000, v132
    v_lshlrev_b32 v242, 16, v133
    v_and_b32 v243, 0xffff0000, v133
    v_fma_f32 v240, v240, v231, v232
    v_fma_f32 v241, v241, v231, v232
    s_waitcnt lgkmcnt(10)
    v_mfma_f32_32x32x16_bf16 v[96:111], v[28:31], v[120:123], v[96:111]
    ds_read_b64_tr_b16 v[20:21], v3 offset:16384
    ds_read_b64_tr_b16 v[22:23], v3 offset:16896
    v_fma_f32 v242, v242, v231, v232
    v_fma_f32 v243, v243, v231, v232
    v_cvt_pk_bf16_f32 v132, v240, v241
    v_cvt_pk_bf16_f32 v133, v242, v243
    v_lshlrev_b32 v244, 16, v134
    v_and_b32 v245, 0xffff0000, v134
    s_waitcnt lgkmcnt(10)
    v_mfma_f32_32x32x16_bf16 v[48:63], v[32:35], v[124:127], v[48:63]
    ds_read_b64_tr_b16 v[24:25], v4 offset:16384
    ds_read_b64_tr_b16 v[26:27], v4 offset:16896
    v_lshlrev_b32 v246, 16, v135
    v_and_b32 v247, 0xffff0000, v135
    v_fma_f32 v244, v244, v231, v232
    v_fma_f32 v245, v245, v231, v232
    v_fma_f32 v246, v246, v231, v232
    v_fma_f32 v247, v247, v231, v232
    s_waitcnt lgkmcnt(10)
    v_mfma_f32_32x32x16_bf16 v[64:79], v[36:39], v[124:127], v[64:79]
    ds_read_b64_tr_b16 v[28:29], v5 offset:16384
    ds_read_b64_tr_b16 v[30:31], v5 offset:16896
    v_cvt_pk_bf16_f32 v134, v244, v245
    v_cvt_pk_bf16_f32 v135, v246, v247
    v_lshlrev_b32 v240, 16, v136
    v_and_b32 v241, 0xffff0000, v136
    v_lshlrev_b32 v242, 16, v137
    v_and_b32 v243, 0xffff0000, v137
    s_waitcnt lgkmcnt(10)
    v_mfma_f32_32x32x16_bf16 v[80:95], v[40:43], v[124:127], v[80:95]
    ds_read_b64_tr_b16 v[32:33], v2 offset:18432
    ds_read_b64_tr_b16 v[34:35], v2 offset:18944
    v_fma_f32 v240, v240, v231, v232
    v_fma_f32 v241, v241, v231, v232
    v_fma_f32 v242, v242, v231, v232
    v_fma_f32 v243, v243, v231, v232
    v_cvt_pk_bf16_f32 v136, v240, v241
    v_cvt_pk_bf16_f32 v137, v242, v243
    s_waitcnt lgkmcnt(10)
    v_mfma_f32_32x32x16_bf16 v[96:111], v[44:47], v[124:127], v[96:111]
    ds_read_b64_tr_b16 v[36:37], v3 offset:18432
    ds_read_b64_tr_b16 v[38:39], v3 offset:18944
    v_lshlrev_b32 v244, 16, v138
    v_and_b32 v245, 0xffff0000, v138
    v_lshlrev_b32 v246, 16, v139
    v_and_b32 v247, 0xffff0000, v139
    v_fma_f32 v244, v244, v231, v232
    v_fma_f32 v245, v245, v231, v232
    s_waitcnt lgkmcnt(10)
    v_mfma_f32_32x32x16_bf16 v[48:63], v[16:19], v[128:131], v[48:63]
    ds_read_b64_tr_b16 v[40:41], v4 offset:18432
    ds_read_b64_tr_b16 v[42:43], v4 offset:18944
    v_fma_f32 v246, v246, v231, v232
    v_fma_f32 v247, v247, v231, v232
    v_cvt_pk_bf16_f32 v138, v244, v245
    v_cvt_pk_bf16_f32 v139, v246, v247
    v_lshlrev_b32 v240, 16, v140
    v_and_b32 v241, 0xffff0000, v140
    s_waitcnt lgkmcnt(10)
    v_mfma_f32_32x32x16_bf16 v[64:79], v[20:23], v[128:131], v[64:79]
    ds_read_b64_tr_b16 v[44:45], v5 offset:18432
    ds_read_b64_tr_b16 v[46:47], v5 offset:18944
    v_lshlrev_b32 v242, 16, v141
    v_and_b32 v243, 0xffff0000, v141
    v_fma_f32 v240, v240, v231, v232
    v_fma_f32 v241, v241, v231, v232
    v_fma_f32 v242, v242, v231, v232
    v_fma_f32 v243, v243, v231, v232
    s_waitcnt lgkmcnt(10)
    v_mfma_f32_32x32x16_bf16 v[80:95], v[24:27], v[128:131], v[80:95]
    ds_read_b64_tr_b16 v[16:17], v2 offset:20480
    ds_read_b64_tr_b16 v[18:19], v2 offset:20992
    v_cvt_pk_bf16_f32 v140, v240, v241
    v_cvt_pk_bf16_f32 v141, v242, v243
    v_lshlrev_b32 v244, 16, v142
    v_and_b32 v245, 0xffff0000, v142
    v_lshlrev_b32 v246, 16, v143
    v_and_b32 v247, 0xffff0000, v143
    s_waitcnt lgkmcnt(10)
    v_mfma_f32_32x32x16_bf16 v[96:111], v[28:31], v[128:131], v[96:111]
    ds_read_b64_tr_b16 v[20:21], v3 offset:20480
    ds_read_b64_tr_b16 v[22:23], v3 offset:20992
    v_fma_f32 v244, v244, v231, v232
    v_fma_f32 v245, v245, v231, v232
    v_fma_f32 v246, v246, v231, v232
    v_fma_f32 v247, v247, v231, v232
    v_cvt_pk_bf16_f32 v142, v244, v245
    v_cvt_pk_bf16_f32 v143, v246, v247
    s_waitcnt lgkmcnt(10)
    v_mfma_f32_32x32x16_bf16 v[48:63], v[32:35], v[132:135], v[48:63]
    ds_read_b64_tr_b16 v[24:25], v4 offset:20480
    ds_read_b64_tr_b16 v[26:27], v4 offset:20992
    v_lshlrev_b32 v240, 16, v144
    v_and_b32 v241, 0xffff0000, v144
    v_lshlrev_b32 v242, 16, v145
    v_and_b32 v243, 0xffff0000, v145
    v_fma_f32 v240, v240, v231, v232
    v_fma_f32 v241, v241, v231, v232
    s_waitcnt lgkmcnt(10)
    v_mfma_f32_32x32x16_bf16 v[64:79], v[36:39], v[132:135], v[64:79]
    ds_read_b64_tr_b16 v[28:29], v5 offset:20480
    ds_read_b64_tr_b16 v[30:31], v5 offset:20992
    v_fma_f32 v242, v242, v231, v232
    v_fma_f32 v243, v243, v231, v232
    v_cvt_pk_bf16_f32 v144, v240, v241
    v_cvt_pk_bf16_f32 v145, v242, v243
    v_lshlrev_b32 v244, 16, v146
    v_and_b32 v245, 0xffff0000, v146
    s_waitcnt lgkmcnt(10)
    v_mfma_f32_32x32x16_bf16 v[80:95], v[40:43], v[132:135], v[80:95]
    ds_read_b64_tr_b16 v[32:33], v2 offset:22528
    ds_read_b64_tr_b16 v[34:35], v2 offset:23040
    v_lshlrev_b32 v246, 16, v147
    v_and_b32 v247, 0xffff0000, v147
    v_fma_f32 v244, v244, v231, v232
    v_fma_f32 v245, v245, v231, v232
    v_fma_f32 v246, v246, v231, v232
    v_fma_f32 v247, v247, v231, v232
    s_waitcnt lgkmcnt(10)
    v_mfma_f32_32x32x16_bf16 v[96:111], v[44:47], v[132:135], v[96:111]
    ds_read_b64_tr_b16 v[36:37], v3 offset:22528
    ds_read_b64_tr_b16 v[38:39], v3 offset:23040
    v_cvt_pk_bf16_f32 v146, v244, v245
    v_cvt_pk_bf16_f32 v147, v246, v247
    v_lshlrev_b32 v240, 16, v148
    v_and_b32 v241, 0xffff0000, v148
    v_lshlrev_b32 v242, 16, v149
    v_and_b32 v243, 0xffff0000, v149
    s_waitcnt lgkmcnt(10)
    v_mfma_f32_32x32x16_bf16 v[48:63], v[16:19], v[136:139], v[48:63]
    ds_read_b64_tr_b16 v[40:41], v4 offset:22528
    ds_read_b64_tr_b16 v[42:43], v4 offset:23040
    v_fma_f32 v240, v240, v231, v232
    v_fma_f32 v241, v241, v231, v232
    v_fma_f32 v242, v242, v231, v232
    v_fma_f32 v243, v243, v231, v232
    v_cvt_pk_bf16_f32 v148, v240, v241
    v_cvt_pk_bf16_f32 v149, v242, v243
    s_waitcnt lgkmcnt(10)
    v_mfma_f32_32x32x16_bf16 v[64:79], v[20:23], v[136:139], v[64:79]
    ds_read_b64_tr_b16 v[44:45], v5 offset:22528
    ds_read_b64_tr_b16 v[46:47], v5 offset:23040
    v_lshlrev_b32 v244, 16, v150
    v_and_b32 v245, 0xffff0000, v150
    v_lshlrev_b32 v246, 16, v151
    v_and_b32 v247, 0xffff0000, v151
    v_fma_f32 v244, v244, v231, v232
    v_fma_f32 v245, v245, v231, v232
    s_waitcnt lgkmcnt(10)
    v_mfma_f32_32x32x16_bf16 v[80:95], v[24:27], v[136:139], v[80:95]
    v_fma_f32 v246, v246, v231, v232
    v_fma_f32 v247, v247, v231, v232
    v_cvt_pk_bf16_f32 v150, v244, v245
    v_cvt_pk_bf16_f32 v151, v246, v247
    v_lshlrev_b32 v240, 16, v152
    v_and_b32 v241, 0xffff0000, v152
    v_lshlrev_b32 v242, 16, v153
    v_and_b32 v243, 0xffff0000, v153
    s_waitcnt lgkmcnt(8)
    v_mfma_f32_32x32x16_bf16 v[96:111], v[28:31], v[136:139], v[96:111]
    v_fma_f32 v240, v240, v231, v232
    v_fma_f32 v241, v241, v231, v232
    v_fma_f32 v242, v242, v231, v232
    v_fma_f32 v243, v243, v231, v232
    v_cvt_pk_bf16_f32 v152, v240, v241
    v_cvt_pk_bf16_f32 v153, v242, v243
    v_lshlrev_b32 v244, 16, v154
    v_and_b32 v245, 0xffff0000, v154
    s_waitcnt lgkmcnt(6)
    v_mfma_f32_32x32x16_bf16 v[48:63], v[32:35], v[140:143], v[48:63]
    s_waitcnt lgkmcnt(0)
    s_barrier
    ds_read_b64_tr_b16 v[16:17], v2 offset:32768
    ds_read_b64_tr_b16 v[18:19], v2 offset:33280
    ds_read_b64_tr_b16 v[20:21], v3 offset:32768
    ds_read_b64_tr_b16 v[22:23], v3 offset:33280
    ds_read_b64_tr_b16 v[24:25], v4 offset:32768
    ds_read_b64_tr_b16 v[26:27], v4 offset:33280
    v_lshlrev_b32 v246, 16, v155
    v_and_b32 v247, 0xffff0000, v155
    v_mfma_f32_32x32x16_bf16 v[64:79], v[36:39], v[140:143], v[64:79]
    ds_read_b64_tr_b16 v[28:29], v5 offset:32768
    ds_read_b64_tr_b16 v[30:31], v5 offset:33280
    v_fma_f32 v244, v244, v231, v232
    v_fma_f32 v245, v245, v231, v232
    v_fma_f32 v246, v246, v231, v232
    v_fma_f32 v247, v247, v231, v232
    v_cvt_pk_bf16_f32 v154, v244, v245
    v_cvt_pk_bf16_f32 v155, v246, v247
    v_mfma_f32_32x32x16_bf16 v[80:95], v[40:43], v[140:143], v[80:95]
    ds_read_b64_tr_b16 v[32:33], v2 offset:34816
    ds_read_b64_tr_b16 v[34:35], v2 offset:35328
    v_lshlrev_b32 v240, 16, v156
    v_and_b32 v241, 0xffff0000, v156
    v_lshlrev_b32 v242, 16, v157
    v_and_b32 v243, 0xffff0000, v157
    v_fma_f32 v240, v240, v231, v232
    v_fma_f32 v241, v241, v231, v232
    v_mfma_f32_32x32x16_bf16 v[96:111], v[44:47], v[140:143], v[96:111]
    ds_read_b64_tr_b16 v[36:37], v3 offset:34816
    ds_read_b64_tr_b16 v[38:39], v3 offset:35328
    v_fma_f32 v242, v242, v231, v232
    v_fma_f32 v243, v243, v231, v232
    v_cvt_pk_bf16_f32 v156, v240, v241
    v_cvt_pk_bf16_f32 v157, v242, v243
    v_lshlrev_b32 v244, 16, v158
    v_and_b32 v245, 0xffff0000, v158
    s_waitcnt lgkmcnt(10)
    v_mfma_f32_32x32x16_bf16 v[48:63], v[16:19], v[144:147], v[48:63]
    ds_read_b64_tr_b16 v[40:41], v4 offset:34816
    ds_read_b64_tr_b16 v[42:43], v4 offset:35328
    v_lshlrev_b32 v246, 16, v159
    v_and_b32 v247, 0xffff0000, v159
    v_fma_f32 v244, v244, v231, v232
    v_fma_f32 v245, v245, v231, v232
    v_fma_f32 v246, v246, v231, v232
    v_fma_f32 v247, v247, v231, v232
    s_waitcnt lgkmcnt(10)
    v_mfma_f32_32x32x16_bf16 v[64:79], v[20:23], v[144:147], v[64:79]
    ds_read_b64_tr_b16 v[44:45], v5 offset:34816
    ds_read_b64_tr_b16 v[46:47], v5 offset:35328
    v_cvt_pk_bf16_f32 v158, v244, v245
    v_cvt_pk_bf16_f32 v159, v246, v247
    v_lshlrev_b32 v240, 16, v160
    v_and_b32 v241, 0xffff0000, v160
    v_lshlrev_b32 v242, 16, v161
    v_and_b32 v243, 0xffff0000, v161
    s_waitcnt lgkmcnt(10)
    v_mfma_f32_32x32x16_bf16 v[80:95], v[24:27], v[144:147], v[80:95]
    ds_read_b64_tr_b16 v[16:17], v2 offset:36864
    ds_read_b64_tr_b16 v[18:19], v2 offset:37376
    v_fma_f32 v240, v240, v231, v232
    v_fma_f32 v241, v241, v231, v232
    v_fma_f32 v242, v242, v231, v232
    v_fma_f32 v243, v243, v231, v232
    v_cvt_pk_bf16_f32 v160, v240, v241
    v_cvt_pk_bf16_f32 v161, v242, v243
    s_waitcnt lgkmcnt(10)
    v_mfma_f32_32x32x16_bf16 v[96:111], v[28:31], v[144:147], v[96:111]
    ds_read_b64_tr_b16 v[20:21], v3 offset:36864
    ds_read_b64_tr_b16 v[22:23], v3 offset:37376
    v_lshlrev_b32 v244, 16, v162
    v_and_b32 v245, 0xffff0000, v162
    v_lshlrev_b32 v246, 16, v163
    v_and_b32 v247, 0xffff0000, v163
    v_fma_f32 v244, v244, v231, v232
    v_fma_f32 v245, v245, v231, v232
    s_waitcnt lgkmcnt(10)
    v_mfma_f32_32x32x16_bf16 v[48:63], v[32:35], v[148:151], v[48:63]
    ds_read_b64_tr_b16 v[24:25], v4 offset:36864
    ds_read_b64_tr_b16 v[26:27], v4 offset:37376
    v_fma_f32 v246, v246, v231, v232
    v_fma_f32 v247, v247, v231, v232
    v_cvt_pk_bf16_f32 v162, v244, v245
    v_cvt_pk_bf16_f32 v163, v246, v247
    v_lshlrev_b32 v240, 16, v164
    v_and_b32 v241, 0xffff0000, v164
    s_waitcnt lgkmcnt(10)
    v_mfma_f32_32x32x16_bf16 v[64:79], v[36:39], v[148:151], v[64:79]
    ds_read_b64_tr_b16 v[28:29], v5 offset:36864
    ds_read_b64_tr_b16 v[30:31], v5 offset:37376
    v_lshlrev_b32 v242, 16, v165
    v_and_b32 v243, 0xffff0000, v165
    v_fma_f32 v240, v240, v231, v232
    v_fma_f32 v241, v241, v231, v232
    v_fma_f32 v242, v242, v231, v232
    v_fma_f32 v243, v243, v231, v232
    s_waitcnt lgkmcnt(10)
    v_mfma_f32_32x32x16_bf16 v[80:95], v[40:43], v[148:151], v[80:95]
    ds_read_b64_tr_b16 v[32:33], v2 offset:38912
    ds_read_b64_tr_b16 v[34:35], v2 offset:39424
    v_cvt_pk_bf16_f32 v164, v240, v241
    v_cvt_pk_bf16_f32 v165, v242, v243
    v_lshlrev_b32 v244, 16, v166
    v_and_b32 v245, 0xffff0000, v166
    v_lshlrev_b32 v246, 16, v167
    v_and_b32 v247, 0xffff0000, v167
    s_waitcnt lgkmcnt(10)
    v_mfma_f32_32x32x16_bf16 v[96:111], v[44:47], v[148:151], v[96:111]
    ds_read_b64_tr_b16 v[36:37], v3 offset:38912
    ds_read_b64_tr_b16 v[38:39], v3 offset:39424
    v_fma_f32 v244, v244, v231, v232
    v_fma_f32 v245, v245, v231, v232
    v_fma_f32 v246, v246, v231, v232
    v_fma_f32 v247, v247, v231, v232
    v_cvt_pk_bf16_f32 v166, v244, v245
    v_cvt_pk_bf16_f32 v167, v246, v247
    s_waitcnt lgkmcnt(10)
    v_mfma_f32_32x32x16_bf16 v[48:63], v[16:19], v[152:155], v[48:63]
    ds_read_b64_tr_b16 v[40:41], v4 offset:38912
    ds_read_b64_tr_b16 v[42:43], v4 offset:39424
    v_lshlrev_b32 v240, 16, v168
    v_and_b32 v241, 0xffff0000, v168
    v_lshlrev_b32 v242, 16, v169
    v_and_b32 v243, 0xffff0000, v169
    v_fma_f32 v240, v240, v231, v232
    v_fma_f32 v241, v241, v231, v232
    s_waitcnt lgkmcnt(10)
    v_mfma_f32_32x32x16_bf16 v[64:79], v[20:23], v[152:155], v[64:79]
    ds_read_b64_tr_b16 v[44:45], v5 offset:38912
    ds_read_b64_tr_b16 v[46:47], v5 offset:39424
    v_fma_f32 v242, v242, v231, v232
    v_fma_f32 v243, v243, v231, v232
    v_cvt_pk_bf16_f32 v168, v240, v241
    v_cvt_pk_bf16_f32 v169, v242, v243
    v_lshlrev_b32 v244, 16, v170
    v_and_b32 v245, 0xffff0000, v170
    s_waitcnt lgkmcnt(10)
    v_mfma_f32_32x32x16_bf16 v[80:95], v[24:27], v[152:155], v[80:95]
    ds_read_b64_tr_b16 v[16:17], v2 offset:49152
    ds_read_b64_tr_b16 v[18:19], v2 offset:49664
    v_lshlrev_b32 v246, 16, v171
    v_and_b32 v247, 0xffff0000, v171
    v_fma_f32 v244, v244, v231, v232
    v_fma_f32 v245, v245, v231, v232
    v_fma_f32 v246, v246, v231, v232
    v_fma_f32 v247, v247, v231, v232
    s_waitcnt lgkmcnt(10)
    v_mfma_f32_32x32x16_bf16 v[96:111], v[28:31], v[152:155], v[96:111]
    ds_read_b64_tr_b16 v[20:21], v3 offset:49152
    ds_read_b64_tr_b16 v[22:23], v3 offset:49664
    v_cvt_pk_bf16_f32 v170, v244, v245
    v_cvt_pk_bf16_f32 v171, v246, v247
    v_lshlrev_b32 v240, 16, v172
    v_and_b32 v241, 0xffff0000, v172
    v_lshlrev_b32 v242, 16, v173
    v_and_b32 v243, 0xffff0000, v173
    s_waitcnt lgkmcnt(10)
    v_mfma_f32_32x32x16_bf16 v[48:63], v[32:35], v[156:159], v[48:63]
    ds_read_b64_tr_b16 v[24:25], v4 offset:49152
    ds_read_b64_tr_b16 v[26:27], v4 offset:49664
    v_fma_f32 v240, v240, v231, v232
    v_fma_f32 v241, v241, v231, v232
    v_fma_f32 v242, v242, v231, v232
    v_fma_f32 v243, v243, v231, v232
    v_cvt_pk_bf16_f32 v172, v240, v241
    v_cvt_pk_bf16_f32 v173, v242, v243
    s_waitcnt lgkmcnt(10)
    v_mfma_f32_32x32x16_bf16 v[64:79], v[36:39], v[156:159], v[64:79]
    ds_read_b64_tr_b16 v[28:29], v5 offset:49152
    ds_read_b64_tr_b16 v[30:31], v5 offset:49664
    v_lshlrev_b32 v244, 16, v174
    v_and_b32 v245, 0xffff0000, v174
    v_lshlrev_b32 v246, 16, v175
    v_and_b32 v247, 0xffff0000, v175
    v_fma_f32 v244, v244, v231, v232
    v_fma_f32 v245, v245, v231, v232
    s_waitcnt lgkmcnt(10)
    v_mfma_f32_32x32x16_bf16 v[80:95], v[40:43], v[156:159], v[80:95]
    ds_read_b64_tr_b16 v[32:33], v2 offset:51200
    ds_read_b64_tr_b16 v[34:35], v2 offset:51712
    v_fma_f32 v246, v246, v231, v232
    v_fma_f32 v247, v247, v231, v232
    v_cvt_pk_bf16_f32 v174, v244, v245
    v_cvt_pk_bf16_f32 v175, v246, v247
    v_lshlrev_b32 v240, 16, v176
    v_and_b32 v241, 0xffff0000, v176
    s_waitcnt lgkmcnt(10)
    v_mfma_f32_32x32x16_bf16 v[96:111], v[44:47], v[156:159], v[96:111]
    ds_read_b64_tr_b16 v[36:37], v3 offset:51200
    ds_read_b64_tr_b16 v[38:39], v3 offset:51712
    v_lshlrev_b32 v242, 16, v177
    v_and_b32 v243, 0xffff0000, v177
    v_fma_f32 v240, v240, v231, v232
    v_fma_f32 v241, v241, v231, v232
    v_fma_f32 v242, v242, v231, v232
    v_fma_f32 v243, v243, v231, v232
    s_waitcnt lgkmcnt(10)
    v_mfma_f32_32x32x16_bf16 v[48:63], v[16:19], v[160:163], v[48:63]
    ds_read_b64_tr_b16 v[40:41], v4 offset:51200
    ds_read_b64_tr_b16 v[42:43], v4 offset:51712
    v_cvt_pk_bf16_f32 v176, v240, v241
    v_cvt_pk_bf16_f32 v177, v242, v243
    v_lshlrev_b32 v244, 16, v178
    v_and_b32 v245, 0xffff0000, v178
    v_lshlrev_b32 v246, 16, v179
    v_and_b32 v247, 0xffff0000, v179
    s_waitcnt lgkmcnt(10)
    v_mfma_f32_32x32x16_bf16 v[64:79], v[20:23], v[160:163], v[64:79]
    ds_read_b64_tr_b16 v[44:45], v5 offset:51200
    ds_read_b64_tr_b16 v[46:47], v5 offset:51712
    v_fma_f32 v244, v244, v231, v232
    v_fma_f32 v245, v245, v231, v232
    v_fma_f32 v246, v246, v231, v232
    v_fma_f32 v247, v247, v231, v232
    v_cvt_pk_bf16_f32 v178, v244, v245
    v_cvt_pk_bf16_f32 v179, v246, v247
    s_waitcnt lgkmcnt(10)
    v_mfma_f32_32x32x16_bf16 v[80:95], v[24:27], v[160:163], v[80:95]
    ds_read_b64_tr_b16 v[16:17], v2 offset:53248
    ds_read_b64_tr_b16 v[18:19], v2 offset:53760
    v_lshlrev_b32 v240, 16, v180
    v_and_b32 v241, 0xffff0000, v180
    v_lshlrev_b32 v242, 16, v181
    v_and_b32 v243, 0xffff0000, v181
    v_fma_f32 v240, v240, v231, v232
    v_fma_f32 v241, v241, v231, v232
    s_waitcnt lgkmcnt(10)
    v_mfma_f32_32x32x16_bf16 v[96:111], v[28:31], v[160:163], v[96:111]
    ds_read_b64_tr_b16 v[20:21], v3 offset:53248
    ds_read_b64_tr_b16 v[22:23], v3 offset:53760
    v_fma_f32 v242, v242, v231, v232
    v_fma_f32 v243, v243, v231, v232
    v_cvt_pk_bf16_f32 v180, v240, v241
    v_cvt_pk_bf16_f32 v181, v242, v243
    v_lshlrev_b32 v244, 16, v182
    v_and_b32 v245, 0xffff0000, v182
    s_waitcnt lgkmcnt(10)
    v_mfma_f32_32x32x16_bf16 v[48:63], v[32:35], v[164:167], v[48:63]
    ds_read_b64_tr_b16 v[24:25], v4 offset:53248
    ds_read_b64_tr_b16 v[26:27], v4 offset:53760
    v_lshlrev_b32 v246, 16, v183
    v_and_b32 v247, 0xffff0000, v183
    v_fma_f32 v244, v244, v231, v232
    v_fma_f32 v245, v245, v231, v232
    v_fma_f32 v246, v246, v231, v232
    v_fma_f32 v247, v247, v231, v232
    s_waitcnt lgkmcnt(10)
    v_mfma_f32_32x32x16_bf16 v[64:79], v[36:39], v[164:167], v[64:79]
    ds_read_b64_tr_b16 v[28:29], v5 offset:53248
    ds_read_b64_tr_b16 v[30:31], v5 offset:53760
    v_cvt_pk_bf16_f32 v182, v244, v245
    v_cvt_pk_bf16_f32 v183, v246, v247
    v_lshlrev_b32 v240, 16, v184
    v_and_b32 v241, 0xffff0000, v184
    v_lshlrev_b32 v242, 16, v185
    v_and_b32 v243, 0xffff0000, v185
    s_waitcnt lgkmcnt(10)
    v_mfma_f32_32x32x16_bf16 v[80:95], v[40:43], v[164:167], v[80:95]
    ds_read_b64_tr_b16 v[32:33], v2 offset:55296
    ds_read_b64_tr_b16 v[34:35], v2 offset:55808
    v_fma_f32 v240, v240, v231, v232
    v_fma_f32 v241, v241, v231, v232
    v_fma_f32 v242, v242, v231, v232
    v_fma_f32 v243, v243, v231, v232
    v_cvt_pk_bf16_f32 v184, v240, v241
    v_cvt_pk_bf16_f32 v185, v242, v243
    s_waitcnt lgkmcnt(10)
    v_mfma_f32_32x32x16_bf16 v[96:111], v[44:47], v[164:167], v[96:111]
    ds_read_b64_tr_b16 v[36:37], v3 offset:55296
    ds_read_b64_tr_b16 v[38:39], v3 offset:55808
    v_lshlrev_b32 v244, 16, v186
    v_and_b32 v245, 0xffff0000, v186
    v_lshlrev_b32 v246, 16, v187
    v_and_b32 v247, 0xffff0000, v187
    v_fma_f32 v244, v244, v231, v232
    v_fma_f32 v245, v245, v231, v232
    s_waitcnt lgkmcnt(10)
    v_mfma_f32_32x32x16_bf16 v[48:63], v[16:19], v[168:171], v[48:63]
    ds_read_b64_tr_b16 v[40:41], v4 offset:55296
    ds_read_b64_tr_b16 v[42:43], v4 offset:55808
    v_fma_f32 v246, v246, v231, v232
    v_fma_f32 v247, v247, v231, v232
    v_cvt_pk_bf16_f32 v186, v244, v245
    v_cvt_pk_bf16_f32 v187, v246, v247
    v_lshlrev_b32 v240, 16, v188
    v_and_b32 v241, 0xffff0000, v188
    s_waitcnt lgkmcnt(10)
    v_mfma_f32_32x32x16_bf16 v[64:79], v[20:23], v[168:171], v[64:79]
    ds_read_b64_tr_b16 v[44:45], v5 offset:55296
    ds_read_b64_tr_b16 v[46:47], v5 offset:55808
    v_lshlrev_b32 v242, 16, v189
    v_and_b32 v243, 0xffff0000, v189
    v_fma_f32 v240, v240, v231, v232
    v_fma_f32 v241, v241, v231, v232
    v_fma_f32 v242, v242, v231, v232
    v_fma_f32 v243, v243, v231, v232
    s_waitcnt lgkmcnt(10)
    v_mfma_f32_32x32x16_bf16 v[80:95], v[24:27], v[168:171], v[80:95]
    v_cvt_pk_bf16_f32 v188, v240, v241
    v_cvt_pk_bf16_f32 v189, v242, v243
    v_lshlrev_b32 v244, 16, v190
    v_and_b32 v245, 0xffff0000, v190
    v_lshlrev_b32 v246, 16, v191
    v_and_b32 v247, 0xffff0000, v191
    v_fma_f32 v244, v244, v231, v232
    v_fma_f32 v245, v245, v231, v232
    s_waitcnt lgkmcnt(8)
    v_mfma_f32_32x32x16_bf16 v[96:111], v[28:31], v[168:171], v[96:111]
    v_fma_f32 v246, v246, v231, v232
    v_fma_f32 v247, v247, v231, v232
    v_cvt_pk_bf16_f32 v190, v244, v245
    v_cvt_pk_bf16_f32 v191, v246, v247
    v_lshlrev_b32 v240, 16, v192
    v_and_b32 v241, 0xffff0000, v192
    v_lshlrev_b32 v242, 16, v193
    v_and_b32 v243, 0xffff0000, v193
    s_waitcnt lgkmcnt(6)
    v_mfma_f32_32x32x16_bf16 v[48:63], v[32:35], v[172:175], v[48:63]
    s_waitcnt lgkmcnt(0)
    s_barrier
    ds_read_b64_tr_b16 v[16:17], v6 offset:0
    ds_read_b64_tr_b16 v[18:19], v6 offset:512
    ds_read_b64_tr_b16 v[20:21], v7 offset:0
    ds_read_b64_tr_b16 v[22:23], v7 offset:512
    ds_read_b64_tr_b16 v[24:25], v8 offset:0
    ds_read_b64_tr_b16 v[26:27], v8 offset:512
    v_fma_f32 v240, v240, v231, v232
    v_fma_f32 v241, v241, v231, v232
    v_mfma_f32_32x32x16_bf16 v[64:79], v[36:39], v[172:175], v[64:79]
    ds_read_b64_tr_b16 v[28:29], v9 offset:0
    ds_read_b64_tr_b16 v[30:31], v9 offset:512
    v_fma_f32 v242, v242, v231, v232
    v_fma_f32 v243, v243, v231, v232
    v_cvt_pk_bf16_f32 v192, v240, v241
    v_cvt_pk_bf16_f32 v193, v242, v243
    v_lshlrev_b32 v244, 16, v194
    v_and_b32 v245, 0xffff0000, v194
    v_mfma_f32_32x32x16_bf16 v[80:95], v[40:43], v[172:175], v[80:95]
    ds_read_b64_tr_b16 v[32:33], v6 offset:2048
    ds_read_b64_tr_b16 v[34:35], v6 offset:2560
    v_lshlrev_b32 v246, 16, v195
    v_and_b32 v247, 0xffff0000, v195
    v_fma_f32 v244, v244, v231, v232
    v_fma_f32 v245, v245, v231, v232
    v_fma_f32 v246, v246, v231, v232
    v_fma_f32 v247, v247, v231, v232
    v_mfma_f32_32x32x16_bf16 v[96:111], v[44:47], v[172:175], v[96:111]
    ds_read_b64_tr_b16 v[36:37], v7 offset:2048
    ds_read_b64_tr_b16 v[38:39], v7 offset:2560
    v_cvt_pk_bf16_f32 v194, v244, v245
    v_cvt_pk_bf16_f32 v195, v246, v247
    v_lshlrev_b32 v240, 16, v196
    v_and_b32 v241, 0xffff0000, v196
    v_lshlrev_b32 v242, 16, v197
    v_and_b32 v243, 0xffff0000, v197
    s_waitcnt lgkmcnt(10)
    v_mfma_f32_32x32x16_bf16 v[48:63], v[16:19], v[176:179], v[48:63]
    ds_read_b64_tr_b16 v[40:41], v8 offset:2048
    ds_read_b64_tr_b16 v[42:43], v8 offset:2560
    v_fma_f32 v240, v240, v231, v232
    v_fma_f32 v241, v241, v231, v232
    v_fma_f32 v242, v242, v231, v232
    v_fma_f32 v243, v243, v231, v232
    v_cvt_pk_bf16_f32 v196, v240, v241
    v_cvt_pk_bf16_f32 v197, v242, v243
    s_waitcnt lgkmcnt(10)
    v_mfma_f32_32x32x16_bf16 v[64:79], v[20:23], v[176:179], v[64:79]
    ds_read_b64_tr_b16 v[44:45], v9 offset:2048
    ds_read_b64_tr_b16 v[46:47], v9 offset:2560
    v_lshlrev_b32 v244, 16, v198
    v_and_b32 v245, 0xffff0000, v198
    v_lshlrev_b32 v246, 16, v199
    v_and_b32 v247, 0xffff0000, v199
    v_fma_f32 v244, v244, v231, v232
    v_fma_f32 v245, v245, v231, v232
    s_waitcnt lgkmcnt(10)
    v_mfma_f32_32x32x16_bf16 v[80:95], v[24:27], v[176:179], v[80:95]
    ds_read_b64_tr_b16 v[16:17], v6 offset:4096
    ds_read_b64_tr_b16 v[18:19], v6 offset:4608
    v_fma_f32 v246, v246, v231, v232
    v_fma_f32 v247, v247, v231, v232
    v_cvt_pk_bf16_f32 v198, v244, v245
    v_cvt_pk_bf16_f32 v199, v246, v247
    v_lshlrev_b32 v240, 16, v200
    v_and_b32 v241, 0xffff0000, v200
    s_waitcnt lgkmcnt(10)
    v_mfma_f32_32x32x16_bf16 v[96:111], v[28:31], v[176:179], v[96:111]
    ds_read_b64_tr_b16 v[20:21], v7 offset:4096
    ds_read_b64_tr_b16 v[22:23], v7 offset:4608
    v_lshlrev_b32 v242, 16, v201
    v_and_b32 v243, 0xffff0000, v201
    v_fma_f32 v240, v240, v231, v232
    v_fma_f32 v241, v241, v231, v232
    v_fma_f32 v242, v242, v231, v232
    v_fma_f32 v243, v243, v231, v232
    s_waitcnt lgkmcnt(10)
    v_mfma_f32_32x32x16_bf16 v[48:63], v[32:35], v[180:183], v[48:63]
    ds_read_b64_tr_b16 v[24:25], v8 offset:4096
    ds_read_b64_tr_b16 v[26:27], v8 offset:4608
    v_cvt_pk_bf16_f32 v200, v240, v241
    v_cvt_pk_bf16_f32 v201, v242, v243
    v_lshlrev_b32 v244, 16, v202
    v_and_b32 v245, 0xffff0000, v202
    v_lshlrev_b32 v246, 16, v203
    v_and_b32 v247, 0xffff0000, v203
    s_waitcnt lgkmcnt(10)
    v_mfma_f32_32x32x16_bf16 v[64:79], v[36:39], v[180:183], v[64:79]
    ds_read_b64_tr_b16 v[28:29], v9 offset:4096
    ds_read_b64_tr_b16 v[30:31], v9 offset:4608
    v_fma_f32 v244, v244, v231, v232
    v_fma_f32 v245, v245, v231, v232
    v_fma_f32 v246, v246, v231, v232
    v_fma_f32 v247, v247, v231, v232
    v_cvt_pk_bf16_f32 v202, v244, v245
    v_cvt_pk_bf16_f32 v203, v246, v247
    s_waitcnt lgkmcnt(10)
    v_mfma_f32_32x32x16_bf16 v[80:95], v[40:43], v[180:183], v[80:95]
    ds_read_b64_tr_b16 v[32:33], v6 offset:6144
    ds_read_b64_tr_b16 v[34:35], v6 offset:6656
    v_lshlrev_b32 v240, 16, v204
    v_and_b32 v241, 0xffff0000, v204
    v_lshlrev_b32 v242, 16, v205
    v_and_b32 v243, 0xffff0000, v205
    v_fma_f32 v240, v240, v231, v232
    v_fma_f32 v241, v241, v231, v232
    s_waitcnt lgkmcnt(10)
    v_mfma_f32_32x32x16_bf16 v[96:111], v[44:47], v[180:183], v[96:111]
    ds_read_b64_tr_b16 v[36:37], v7 offset:6144
    ds_read_b64_tr_b16 v[38:39], v7 offset:6656
    v_fma_f32 v242, v242, v231, v232
    v_fma_f32 v243, v243, v231, v232
    v_cvt_pk_bf16_f32 v204, v240, v241
    v_cvt_pk_bf16_f32 v205, v242, v243
    v_lshlrev_b32 v244, 16, v206
    v_and_b32 v245, 0xffff0000, v206
    s_waitcnt lgkmcnt(10)
    v_mfma_f32_32x32x16_bf16 v[48:63], v[16:19], v[184:187], v[48:63]
    ds_read_b64_tr_b16 v[40:41], v8 offset:6144
    ds_read_b64_tr_b16 v[42:43], v8 offset:6656
    v_lshlrev_b32 v246, 16, v207
    v_and_b32 v247, 0xffff0000, v207
    v_fma_f32 v244, v244, v231, v232
    v_fma_f32 v245, v245, v231, v232
    v_fma_f32 v246, v246, v231, v232
    v_fma_f32 v247, v247, v231, v232
    s_waitcnt lgkmcnt(10)
    v_mfma_f32_32x32x16_bf16 v[64:79], v[20:23], v[184:187], v[64:79]
    ds_read_b64_tr_b16 v[44:45], v9 offset:6144
    ds_read_b64_tr_b16 v[46:47], v9 offset:6656
    v_cvt_pk_bf16_f32 v206, v244, v245
    v_cvt_pk_bf16_f32 v207, v246, v247
    v_lshlrev_b32 v240, 16, v208
    v_and_b32 v241, 0xffff0000, v208
    v_lshlrev_b32 v242, 16, v209
    v_and_b32 v243, 0xffff0000, v209
    s_waitcnt lgkmcnt(10)
    v_mfma_f32_32x32x16_bf16 v[80:95], v[24:27], v[184:187], v[80:95]
    ds_read_b64_tr_b16 v[16:17], v6 offset:16384
    ds_read_b64_tr_b16 v[18:19], v6 offset:16896
    v_fma_f32 v240, v240, v231, v232
    v_fma_f32 v241, v241, v231, v232
    v_fma_f32 v242, v242, v231, v232
    v_fma_f32 v243, v243, v231, v232
    v_cvt_pk_bf16_f32 v208, v240, v241
    v_cvt_pk_bf16_f32 v209, v242, v243
    s_waitcnt lgkmcnt(10)
    v_mfma_f32_32x32x16_bf16 v[96:111], v[28:31], v[184:187], v[96:111]
    ds_read_b64_tr_b16 v[20:21], v7 offset:16384
    ds_read_b64_tr_b16 v[22:23], v7 offset:16896
    v_lshlrev_b32 v244, 16, v210
    v_and_b32 v245, 0xffff0000, v210
    v_lshlrev_b32 v246, 16, v211
    v_and_b32 v247, 0xffff0000, v211
    v_fma_f32 v244, v244, v231, v232
    v_fma_f32 v245, v245, v231, v232
    s_waitcnt lgkmcnt(10)
    v_mfma_f32_32x32x16_bf16 v[48:63], v[32:35], v[188:191], v[48:63]
    ds_read_b64_tr_b16 v[24:25], v8 offset:16384
    ds_read_b64_tr_b16 v[26:27], v8 offset:16896
    v_fma_f32 v246, v246, v231, v232
    v_fma_f32 v247, v247, v231, v232
    v_cvt_pk_bf16_f32 v210, v244, v245
    v_cvt_pk_bf16_f32 v211, v246, v247
    v_lshlrev_b32 v240, 16, v212
    v_and_b32 v241, 0xffff0000, v212
    s_waitcnt lgkmcnt(10)
    v_mfma_f32_32x32x16_bf16 v[64:79], v[36:39], v[188:191], v[64:79]
    ds_read_b64_tr_b16 v[28:29], v9 offset:16384
    ds_read_b64_tr_b16 v[30:31], v9 offset:16896
    v_lshlrev_b32 v242, 16, v213
    v_and_b32 v243, 0xffff0000, v213
    v_fma_f32 v240, v240, v231, v232
    v_fma_f32 v241, v241, v231, v232
    v_fma_f32 v242, v242, v231, v232
    v_fma_f32 v243, v243, v231, v232
    s_waitcnt lgkmcnt(10)
    v_mfma_f32_32x32x16_bf16 v[80:95], v[40:43], v[188:191], v[80:95]
    ds_read_b64_tr_b16 v[32:33], v6 offset:18432
    ds_read_b64_tr_b16 v[34:35], v6 offset:18944
    v_cvt_pk_bf16_f32 v212, v240, v241
    v_cvt_pk_bf16_f32 v213, v242, v243
    v_lshlrev_b32 v244, 16, v214
    v_and_b32 v245, 0xffff0000, v214
    v_lshlrev_b32 v246, 16, v215
    v_and_b32 v247, 0xffff0000, v215
    s_waitcnt lgkmcnt(10)
    v_mfma_f32_32x32x16_bf16 v[96:111], v[44:47], v[188:191], v[96:111]
    ds_read_b64_tr_b16 v[36:37], v7 offset:18432
    ds_read_b64_tr_b16 v[38:39], v7 offset:18944
    v_fma_f32 v244, v244, v231, v232
    v_fma_f32 v245, v245, v231, v232
    v_fma_f32 v246, v246, v231, v232
    v_fma_f32 v247, v247, v231, v232
    v_cvt_pk_bf16_f32 v214, v244, v245
    v_cvt_pk_bf16_f32 v215, v246, v247
    s_waitcnt lgkmcnt(10)
    v_mfma_f32_32x32x16_bf16 v[48:63], v[16:19], v[192:195], v[48:63]
    ds_read_b64_tr_b16 v[40:41], v8 offset:18432
    ds_read_b64_tr_b16 v[42:43], v8 offset:18944
    v_lshlrev_b32 v240, 16, v216
    v_and_b32 v241, 0xffff0000, v216
    v_lshlrev_b32 v242, 16, v217
    v_and_b32 v243, 0xffff0000, v217
    v_fma_f32 v240, v240, v231, v232
    v_fma_f32 v241, v241, v231, v232
    s_waitcnt lgkmcnt(10)
    v_mfma_f32_32x32x16_bf16 v[64:79], v[20:23], v[192:195], v[64:79]
    ds_read_b64_tr_b16 v[44:45], v9 offset:18432
    ds_read_b64_tr_b16 v[46:47], v9 offset:18944
    v_fma_f32 v242, v242, v231, v232
    v_fma_f32 v243, v243, v231, v232
    v_cvt_pk_bf16_f32 v216, v240, v241
    v_cvt_pk_bf16_f32 v217, v242, v243
    v_lshlrev_b32 v244, 16, v218
    v_and_b32 v245, 0xffff0000, v218
    s_waitcnt lgkmcnt(10)
    v_mfma_f32_32x32x16_bf16 v[80:95], v[24:27], v[192:195], v[80:95]
    ds_read_b64_tr_b16 v[16:17], v6 offset:20480
    ds_read_b64_tr_b16 v[18:19], v6 offset:20992
    v_lshlrev_b32 v246, 16, v219
    v_and_b32 v247, 0xffff0000, v219
    v_fma_f32 v244, v244, v231, v232
    v_fma_f32 v245, v245, v231, v232
    v_fma_f32 v246, v246, v231, v232
    v_fma_f32 v247, v247, v231, v232
    s_waitcnt lgkmcnt(10)
    v_mfma_f32_32x32x16_bf16 v[96:111], v[28:31], v[192:195], v[96:111]
    ds_read_b64_tr_b16 v[20:21], v7 offset:20480
    ds_read_b64_tr_b16 v[22:23], v7 offset:20992
    v_cvt_pk_bf16_f32 v218, v244, v245
    v_cvt_pk_bf16_f32 v219, v246, v247
    v_lshlrev_b32 v240, 16, v220
    v_and_b32 v241, 0xffff0000, v220
    v_lshlrev_b32 v242, 16, v221
    v_and_b32 v243, 0xffff0000, v221
    s_waitcnt lgkmcnt(10)
    v_mfma_f32_32x32x16_bf16 v[48:63], v[32:35], v[196:199], v[48:63]
    ds_read_b64_tr_b16 v[24:25], v8 offset:20480
    ds_read_b64_tr_b16 v[26:27], v8 offset:20992
    v_fma_f32 v240, v240, v231, v232
    v_fma_f32 v241, v241, v231, v232
    v_fma_f32 v242, v242, v231, v232
    v_fma_f32 v243, v243, v231, v232
    v_cvt_pk_bf16_f32 v220, v240, v241
    v_cvt_pk_bf16_f32 v221, v242, v243
    s_waitcnt lgkmcnt(10)
    v_mfma_f32_32x32x16_bf16 v[64:79], v[36:39], v[196:199], v[64:79]
    ds_read_b64_tr_b16 v[28:29], v9 offset:20480
    ds_read_b64_tr_b16 v[30:31], v9 offset:20992
    v_lshlrev_b32 v244, 16, v222
    v_and_b32 v245, 0xffff0000, v222
    v_lshlrev_b32 v246, 16, v223
    v_and_b32 v247, 0xffff0000, v223
    v_fma_f32 v244, v244, v231, v232
    v_fma_f32 v245, v245, v231, v232
    s_waitcnt lgkmcnt(10)
    v_mfma_f32_32x32x16_bf16 v[80:95], v[40:43], v[196:199], v[80:95]
    ds_read_b64_tr_b16 v[32:33], v6 offset:22528
    ds_read_b64_tr_b16 v[34:35], v6 offset:23040
    v_fma_f32 v246, v246, v231, v232
    v_fma_f32 v247, v247, v231, v232
    v_cvt_pk_bf16_f32 v222, v244, v245
    v_cvt_pk_bf16_f32 v223, v246, v247
    s_waitcnt lgkmcnt(10)
    v_mfma_f32_32x32x16_bf16 v[96:111], v[44:47], v[196:199], v[96:111]
    ds_read_b64_tr_b16 v[36:37], v7 offset:22528
    ds_read_b64_tr_b16 v[38:39], v7 offset:23040
    s_waitcnt lgkmcnt(10)
    v_mfma_f32_32x32x16_bf16 v[48:63], v[16:19], v[200:203], v[48:63]
    ds_read_b64_tr_b16 v[40:41], v8 offset:22528
    ds_read_b64_tr_b16 v[42:43], v8 offset:23040
    s_waitcnt lgkmcnt(10)
    v_mfma_f32_32x32x16_bf16 v[64:79], v[20:23], v[200:203], v[64:79]
    ds_read_b64_tr_b16 v[44:45], v9 offset:22528
    ds_read_b64_tr_b16 v[46:47], v9 offset:23040
    s_waitcnt lgkmcnt(10)
    v_mfma_f32_32x32x16_bf16 v[80:95], v[24:27], v[200:203], v[80:95]
    s_waitcnt lgkmcnt(8)
    v_mfma_f32_32x32x16_bf16 v[96:111], v[28:31], v[200:203], v[96:111]
    s_waitcnt lgkmcnt(6)
    v_mfma_f32_32x32x16_bf16 v[48:63], v[32:35], v[204:207], v[48:63]
    s_waitcnt lgkmcnt(0)
    s_barrier
    ds_read_b64_tr_b16 v[16:17], v2 offset:0
    ds_read_b64_tr_b16 v[18:19], v2 offset:512
    ds_read_b64_tr_b16 v[20:21], v2 offset:2048
    ds_read_b64_tr_b16 v[22:23], v2 offset:2560
    ds_read_b64_tr_b16 v[24:25], v2 offset:4096
    ds_read_b64_tr_b16 v[26:27], v2 offset:4608
    v_mfma_f32_32x32x16_bf16 v[64:79], v[36:39], v[204:207], v[64:79]
    ds_read_b64_tr_b16 v[28:29], v2 offset:6144
    ds_read_b64_tr_b16 v[30:31], v2 offset:6656
    v_mfma_f32_32x32x16_bf16 v[80:95], v[40:43], v[204:207], v[80:95]
    ds_read_b64_tr_b16 v[32:33], v3 offset:0
    ds_read_b64_tr_b16 v[34:35], v3 offset:512
    v_mfma_f32_32x32x16_bf16 v[96:111], v[44:47], v[204:207], v[96:111]
    ds_read_b64_tr_b16 v[36:37], v3 offset:2048
    ds_read_b64_tr_b16 v[38:39], v3 offset:2560
    s_waitcnt lgkmcnt(10)
    v_mfma_f32_32x32x16_bf16 v[48:63], v[16:19], v[208:211], v[48:63]
    ds_read_b64_tr_b16 v[40:41], v3 offset:4096
    ds_read_b64_tr_b16 v[42:43], v3 offset:4608
    s_waitcnt lgkmcnt(10)
    v_mfma_f32_32x32x16_bf16 v[48:63], v[20:23], v[212:215], v[48:63]
    ds_read_b64_tr_b16 v[44:45], v3 offset:6144
    ds_read_b64_tr_b16 v[46:47], v3 offset:6656
    s_waitcnt lgkmcnt(10)
    v_mfma_f32_32x32x16_bf16 v[48:63], v[24:27], v[216:219], v[48:63]
    ds_read_b64_tr_b16 v[16:17], v4 offset:0
    ds_read_b64_tr_b16 v[18:19], v4 offset:512
    s_waitcnt lgkmcnt(10)
    v_mfma_f32_32x32x16_bf16 v[48:63], v[28:31], v[220:223], v[48:63]
    ds_read_b64_tr_b16 v[20:21], v4 offset:2048
    ds_read_b64_tr_b16 v[22:23], v4 offset:2560
    s_waitcnt lgkmcnt(10)
    v_mfma_f32_32x32x16_bf16 v[64:79], v[32:35], v[208:211], v[64:79]
    ds_read_b64_tr_b16 v[24:25], v4 offset:4096
    ds_read_b64_tr_b16 v[26:27], v4 offset:4608
    s_waitcnt lgkmcnt(10)
    v_mfma_f32_32x32x16_bf16 v[64:79], v[36:39], v[212:215], v[64:79]
    ds_read_b64_tr_b16 v[28:29], v4 offset:6144
    ds_read_b64_tr_b16 v[30:31], v4 offset:6656
    s_nop 1
    v_mul_f32 v48, v48, v56
    v_mul_f32 v49, v49, v57
    v_mul_f32 v50, v50, v58
    v_mul_f32 v51, v51, v59
    s_waitcnt lgkmcnt(10)
    v_mfma_f32_32x32x16_bf16 v[64:79], v[40:43], v[216:219], v[64:79]
    ds_read_b64_tr_b16 v[32:33], v5 offset:0
    ds_read_b64_tr_b16 v[34:35], v5 offset:512
    v_mul_f32 v52, v52, v60
    v_mul_f32 v53, v53, v61
    v_mul_f32 v54, v54, v62
    v_mul_f32 v55, v55, v63
    s_waitcnt lgkmcnt(10)
    v_mfma_f32_32x32x16_bf16 v[64:79], v[44:47], v[220:223], v[64:79]
    ds_read_b64_tr_b16 v[36:37], v5 offset:2048
    ds_read_b64_tr_b16 v[38:39], v5 offset:2560
    v_cvt_pk_bf16_f32 v240, v48, v49
    v_cvt_pk_bf16_f32 v241, v50, v51
    v_cvt_pk_bf16_f32 v242, v52, v53
    v_cvt_pk_bf16_f32 v243, v54, v55
    s_waitcnt lgkmcnt(10)
    v_mfma_f32_32x32x16_bf16 v[80:95], v[16:19], v[208:211], v[80:95]
    ds_read_b64_tr_b16 v[40:41], v5 offset:4096
    ds_read_b64_tr_b16 v[42:43], v5 offset:4608
    s_waitcnt lgkmcnt(10)
    v_mfma_f32_32x32x16_bf16 v[80:95], v[20:23], v[212:215], v[80:95]
    ds_read_b64_tr_b16 v[44:45], v5 offset:6144
    ds_read_b64_tr_b16 v[46:47], v5 offset:6656
    v_mul_f32 v64, v64, v72
    v_mul_f32 v65, v65, v73
    v_mul_f32 v66, v66, v74
    v_mul_f32 v67, v67, v75
    s_waitcnt lgkmcnt(10)
    v_mfma_f32_32x32x16_bf16 v[80:95], v[24:27], v[216:219], v[80:95]
    ds_read_b64_tr_b16 v[16:17], v2 offset:16384
    ds_read_b64_tr_b16 v[18:19], v2 offset:16896
    v_mul_f32 v68, v68, v76
    v_mul_f32 v69, v69, v77
    v_mul_f32 v70, v70, v78
    v_mul_f32 v71, v71, v79
    s_waitcnt lgkmcnt(10)
    v_mfma_f32_32x32x16_bf16 v[80:95], v[28:31], v[220:223], v[80:95]
    ds_read_b64_tr_b16 v[20:21], v2 offset:18432
    ds_read_b64_tr_b16 v[22:23], v2 offset:18944
    v_cvt_pk_bf16_f32 v244, v64, v65
    v_cvt_pk_bf16_f32 v245, v66, v67
    v_cvt_pk_bf16_f32 v246, v68, v69
    v_cvt_pk_bf16_f32 v247, v70, v71
    s_waitcnt lgkmcnt(10)
    v_mfma_f32_32x32x16_bf16 v[96:111], v[32:35], v[208:211], v[96:111]
    ds_read_b64_tr_b16 v[24:25], v2 offset:20480
    ds_read_b64_tr_b16 v[26:27], v2 offset:20992
    s_waitcnt lgkmcnt(10)
    v_mfma_f32_32x32x16_bf16 v[96:111], v[36:39], v[212:215], v[96:111]
    ds_read_b64_tr_b16 v[28:29], v2 offset:22528
    ds_read_b64_tr_b16 v[30:31], v2 offset:23040
    v_mul_f32 v80, v80, v88
    v_mul_f32 v81, v81, v89
    v_mul_f32 v82, v82, v90
    v_mul_f32 v83, v83, v91
    s_waitcnt lgkmcnt(10)
    v_mfma_f32_32x32x16_bf16 v[96:111], v[40:43], v[216:219], v[96:111]
    ds_read_b64_tr_b16 v[32:33], v3 offset:16384
    ds_read_b64_tr_b16 v[34:35], v3 offset:16896
    v_mul_f32 v84, v84, v92
    v_mul_f32 v85, v85, v93
    v_mul_f32 v86, v86, v94
    v_mul_f32 v87, v87, v95
    s_waitcnt lgkmcnt(10)
    v_mfma_f32_32x32x16_bf16 v[96:111], v[44:47], v[220:223], v[96:111]
    ds_read_b64_tr_b16 v[36:37], v3 offset:18432
    ds_read_b64_tr_b16 v[38:39], v3 offset:18944
    v_cvt_pk_bf16_f32 v248, v80, v81
    v_cvt_pk_bf16_f32 v249, v82, v83
    v_cvt_pk_bf16_f32 v250, v84, v85
    v_cvt_pk_bf16_f32 v251, v86, v87
    s_waitcnt lgkmcnt(10)
    v_mfma_f32_32x32x16_bf16 v[48:63], v[16:19], v[112:115], 0
    ds_read_b64_tr_b16 v[40:41], v3 offset:20480
    ds_read_b64_tr_b16 v[42:43], v3 offset:20992
    s_waitcnt lgkmcnt(10)
    v_mfma_f32_32x32x16_bf16 v[48:63], v[20:23], v[116:119], v[48:63]
    ds_read_b64_tr_b16 v[44:45], v3 offset:22528
    ds_read_b64_tr_b16 v[46:47], v3 offset:23040
    v_mul_f32 v96, v96, v104
    v_mul_f32 v97, v97, v105
    v_mul_f32 v98, v98, v106
    v_mul_f32 v99, v99, v107
    s_waitcnt lgkmcnt(10)
    v_mfma_f32_32x32x16_bf16 v[48:63], v[24:27], v[120:123], v[48:63]
    ds_read_b64_tr_b16 v[16:17], v4 offset:16384
    ds_read_b64_tr_b16 v[18:19], v4 offset:16896
    v_mul_f32 v100, v100, v108
    v_mul_f32 v101, v101, v109
    v_mul_f32 v102, v102, v110
    v_mul_f32 v103, v103, v111
    s_waitcnt lgkmcnt(10)
    v_mfma_f32_32x32x16_bf16 v[48:63], v[28:31], v[124:127], v[48:63]
    ds_read_b64_tr_b16 v[20:21], v4 offset:18432
    ds_read_b64_tr_b16 v[22:23], v4 offset:18944
    v_cvt_pk_bf16_f32 v252, v96, v97
    v_cvt_pk_bf16_f32 v253, v98, v99
    v_cvt_pk_bf16_f32 v254, v100, v101
    v_cvt_pk_bf16_f32 v255, v102, v103
    s_waitcnt lgkmcnt(10)
    v_mfma_f32_32x32x16_bf16 v[64:79], v[32:35], v[112:115], 0
    ds_read_b64_tr_b16 v[24:25], v4 offset:20480
    ds_read_b64_tr_b16 v[26:27], v4 offset:20992
    s_waitcnt lgkmcnt(10)
    v_mfma_f32_32x32x16_bf16 v[64:79], v[36:39], v[116:119], v[64:79]
    ds_read_b64_tr_b16 v[28:29], v4 offset:22528
    ds_read_b64_tr_b16 v[30:31], v4 offset:23040
    s_waitcnt lgkmcnt(10)
    v_mfma_f32_32x32x16_bf16 v[64:79], v[40:43], v[120:123], v[64:79]
    ds_read_b64_tr_b16 v[32:33], v5 offset:16384
    ds_read_b64_tr_b16 v[34:35], v5 offset:16896
    buffer_store_dwordx4 v[240:243], v1, s[40:43], s51 offen offset:0 sc1
    s_waitcnt lgkmcnt(10)
    v_mfma_f32_32x32x16_bf16 v[64:79], v[44:47], v[124:127], v[64:79]
    ds_read_b64_tr_b16 v[36:37], v5 offset:18432
    ds_read_b64_tr_b16 v[38:39], v5 offset:18944
    buffer_store_dwordx4 v[244:247], v1, s[40:43], s51 offen offset:1024 sc1
    s_waitcnt lgkmcnt(10)
    v_mfma_f32_32x32x16_bf16 v[80:95], v[16:19], v[112:115], 0
    ds_read_b64_tr_b16 v[40:41], v5 offset:20480
    ds_read_b64_tr_b16 v[42:43], v5 offset:20992
    buffer_store_dwordx4 v[248:251], v1, s[40:43], s51 offen offset:2048 sc1
    s_waitcnt lgkmcnt(10)
    v_mfma_f32_32x32x16_bf16 v[80:95], v[20:23], v[116:119], v[80:95]
    ds_read_b64_tr_b16 v[44:45], v5 offset:22528
    ds_read_b64_tr_b16 v[46:47], v5 offset:23040
    buffer_store_dwordx4 v[252:255], v1, s[40:43], s51 offen offset:3072 sc1
    s_waitcnt lgkmcnt(10)
    v_mfma_f32_32x32x16_bf16 v[80:95], v[24:27], v[120:123], v[80:95]
    s_waitcnt lgkmcnt(8)
    v_mfma_f32_32x32x16_bf16 v[80:95], v[28:31], v[124:127], v[80:95]
    s_waitcnt lgkmcnt(6)
    v_mfma_f32_32x32x16_bf16 v[96:111], v[32:35], v[112:115], 0
    s_waitcnt lgkmcnt(0)
    s_barrier
    ds_read_b64_tr_b16 v[16:17], v2 offset:32768
    ds_read_b64_tr_b16 v[18:19], v2 offset:33280
    ds_read_b64_tr_b16 v[20:21], v3 offset:32768
    ds_read_b64_tr_b16 v[22:23], v3 offset:33280
    ds_read_b64_tr_b16 v[24:25], v4 offset:32768
    ds_read_b64_tr_b16 v[26:27], v4 offset:33280
    v_mfma_f32_32x32x16_bf16 v[96:111], v[36:39], v[116:119], v[96:111]
    ds_read_b64_tr_b16 v[28:29], v5 offset:32768
    ds_read_b64_tr_b16 v[30:31], v5 offset:33280
    v_mfma_f32_32x32x16_bf16 v[96:111], v[40:43], v[120:123], v[96:111]
    ds_read_b64_tr_b16 v[32:33], v2 offset:34816
    ds_read_b64_tr_b16 v[34:35], v2 offset:35328
    v_mfma_f32_32x32x16_bf16 v[96:111], v[44:47], v[124:127], v[96:111]
    ds_read_b64_tr_b16 v[36:37], v3 offset:34816
    ds_read_b64_tr_b16 v[38:39], v3 offset:35328
    s_waitcnt lgkmcnt(10)
    v_mfma_f32_32x32x16_bf16 v[48:63], v[16:19], v[128:131], v[48:63]
    ds_read_b64_tr_b16 v[40:41], v4 offset:34816
    ds_read_b64_tr_b16 v[42:43], v4 offset:35328
    s_waitcnt lgkmcnt(10)
    v_mfma_f32_32x32x16_bf16 v[64:79], v[20:23], v[128:131], v[64:79]
    ds_read_b64_tr_b16 v[44:45], v5 offset:34816
    ds_read_b64_tr_b16 v[46:47], v5 offset:35328
    s_waitcnt lgkmcnt(10)
    v_mfma_f32_32x32x16_bf16 v[80:95], v[24:27], v[128:131], v[80:95]
    ds_read_b64_tr_b16 v[16:17], v2 offset:36864
    ds_read_b64_tr_b16 v[18:19], v2 offset:37376
    s_waitcnt lgkmcnt(10)
    v_mfma_f32_32x32x16_bf16 v[96:111], v[28:31], v[128:131], v[96:111]
    ds_read_b64_tr_b16 v[20:21], v3 offset:36864
    ds_read_b64_tr_b16 v[22:23], v3 offset:37376
    s_waitcnt lgkmcnt(10)
    v_mfma_f32_32x32x16_bf16 v[48:63], v[32:35], v[132:135], v[48:63]
    ds_read_b64_tr_b16 v[24:25], v4 offset:36864
    ds_read_b64_tr_b16 v[26:27], v4 offset:37376
    s_waitcnt lgkmcnt(10)
    v_mfma_f32_32x32x16_bf16 v[64:79], v[36:39], v[132:135], v[64:79]
    ds_read_b64_tr_b16 v[28:29], v5 offset:36864
    ds_read_b64_tr_b16 v[30:31], v5 offset:37376
    s_waitcnt lgkmcnt(10)
    v_mfma_f32_32x32x16_bf16 v[80:95], v[40:43], v[132:135], v[80:95]
    ds_read_b64_tr_b16 v[32:33], v2 offset:38912
    ds_read_b64_tr_b16 v[34:35], v2 offset:39424
    s_waitcnt lgkmcnt(10)
    v_mfma_f32_32x32x16_bf16 v[96:111], v[44:47], v[132:135], v[96:111]
    ds_read_b64_tr_b16 v[36:37], v3 offset:38912
    ds_read_b64_tr_b16 v[38:39], v3 offset:39424
    s_waitcnt lgkmcnt(10)
    v_mfma_f32_32x32x16_bf16 v[48:63], v[16:19], v[136:139], v[48:63]
    ds_read_b64_tr_b16 v[40:41], v4 offset:38912
    ds_read_b64_tr_b16 v[42:43], v4 offset:39424
    s_waitcnt lgkmcnt(10)
    v_mfma_f32_32x32x16_bf16 v[64:79], v[20:23], v[136:139], v[64:79]
    ds_read_b64_tr_b16 v[44:45], v5 offset:38912
    ds_read_b64_tr_b16 v[46:47], v5 offset:39424
    s_waitcnt lgkmcnt(10)
    v_mfma_f32_32x32x16_bf16 v[80:95], v[24:27], v[136:139], v[80:95]
    ds_read_b64_tr_b16 v[16:17], v2 offset:49152
    ds_read_b64_tr_b16 v[18:19], v2 offset:49664
    s_waitcnt lgkmcnt(10)
    v_mfma_f32_32x32x16_bf16 v[96:111], v[28:31], v[136:139], v[96:111]
    ds_read_b64_tr_b16 v[20:21], v3 offset:49152
    ds_read_b64_tr_b16 v[22:23], v3 offset:49664
    s_waitcnt lgkmcnt(10)
    v_mfma_f32_32x32x16_bf16 v[48:63], v[32:35], v[140:143], v[48:63]
    ds_read_b64_tr_b16 v[24:25], v4 offset:49152
    ds_read_b64_tr_b16 v[26:27], v4 offset:49664
    s_waitcnt vmcnt(0)
    s_mov_b64 exec, 255
    buffer_store_dwordx4 v[12:15], v1, s[40:43], s3 offen sc1
    s_mov_b64 exec, -1
    s_add_u32 s3, s3, 131072
    s_add_u32 s51, s51, 57344
    s_waitcnt lgkmcnt(10)
    v_mfma_f32_32x32x16_bf16 v[64:79], v[36:39], v[140:143], v[64:79]
    ds_read_b64_tr_b16 v[28:29], v5 offset:49152
    ds_read_b64_tr_b16 v[30:31], v5 offset:49664
    s_waitcnt lgkmcnt(10)
    v_mfma_f32_32x32x16_bf16 v[80:95], v[40:43], v[140:143], v[80:95]
    ds_read_b64_tr_b16 v[32:33], v2 offset:51200
    ds_read_b64_tr_b16 v[34:35], v2 offset:51712
    s_waitcnt lgkmcnt(10)
    v_mfma_f32_32x32x16_bf16 v[96:111], v[44:47], v[140:143], v[96:111]
    ds_read_b64_tr_b16 v[36:37], v3 offset:51200
    ds_read_b64_tr_b16 v[38:39], v3 offset:51712
    s_waitcnt lgkmcnt(10)
    v_mfma_f32_32x32x16_bf16 v[48:63], v[16:19], v[144:147], v[48:63]
    ds_read_b64_tr_b16 v[40:41], v4 offset:51200
    ds_read_b64_tr_b16 v[42:43], v4 offset:51712
    s_waitcnt lgkmcnt(10)
    v_mfma_f32_32x32x16_bf16 v[64:79], v[20:23], v[144:147], v[64:79]
    ds_read_b64_tr_b16 v[44:45], v5 offset:51200
    ds_read_b64_tr_b16 v[46:47], v5 offset:51712
    s_waitcnt lgkmcnt(10)
    v_mfma_f32_32x32x16_bf16 v[80:95], v[24:27], v[144:147], v[80:95]
    ds_read_b64_tr_b16 v[16:17], v2 offset:53248
    ds_read_b64_tr_b16 v[18:19], v2 offset:53760
    s_waitcnt lgkmcnt(10)
    v_mfma_f32_32x32x16_bf16 v[96:111], v[28:31], v[144:147], v[96:111]
    ds_read_b64_tr_b16 v[20:21], v3 offset:53248
    ds_read_b64_tr_b16 v[22:23], v3 offset:53760
    s_waitcnt lgkmcnt(10)
    v_mfma_f32_32x32x16_bf16 v[48:63], v[32:35], v[148:151], v[48:63]
    ds_read_b64_tr_b16 v[24:25], v4 offset:53248
    ds_read_b64_tr_b16 v[26:27], v4 offset:53760
    s_waitcnt lgkmcnt(10)
    v_mfma_f32_32x32x16_bf16 v[64:79], v[36:39], v[148:151], v[64:79]
    ds_read_b64_tr_b16 v[28:29], v5 offset:53248
    ds_read_b64_tr_b16 v[30:31], v5 offset:53760
    s_waitcnt lgkmcnt(10)
    v_mfma_f32_32x32x16_bf16 v[80:95], v[40:43], v[148:151], v[80:95]
    ds_read_b64_tr_b16 v[32:33], v2 offset:55296
    ds_read_b64_tr_b16 v[34:35], v2 offset:55808
    s_waitcnt lgkmcnt(10)
    v_mfma_f32_32x32x16_bf16 v[96:111], v[44:47], v[148:151], v[96:111]
    ds_read_b64_tr_b16 v[36:37], v3 offset:55296
    ds_read_b64_tr_b16 v[38:39], v3 offset:55808
    s_waitcnt lgkmcnt(10)
    v_mfma_f32_32x32x16_bf16 v[48:63], v[16:19], v[152:155], v[48:63]
    ds_read_b64_tr_b16 v[40:41], v4 offset:55296
    ds_read_b64_tr_b16 v[42:43], v4 offset:55808
    s_waitcnt lgkmcnt(10)
    v_mfma_f32_32x32x16_bf16 v[64:79], v[20:23], v[152:155], v[64:79]
    ds_read_b64_tr_b16 v[44:45], v5 offset:55296
    ds_read_b64_tr_b16 v[46:47], v5 offset:55808
    s_waitcnt lgkmcnt(10)
    v_mfma_f32_32x32x16_bf16 v[80:95], v[24:27], v[152:155], v[80:95]
    s_waitcnt lgkmcnt(8)
    v_mfma_f32_32x32x16_bf16 v[96:111], v[28:31], v[152:155], v[96:111]
    s_waitcnt lgkmcnt(6)
    v_mfma_f32_32x32x16_bf16 v[48:63], v[32:35], v[156:159], v[48:63]
    s_waitcnt lgkmcnt(0)
    s_barrier
    ds_read_b64_tr_b16 v[16:17], v6 offset:0
    ds_read_b64_tr_b16 v[18:19], v6 offset:512
    ds_read_b64_tr_b16 v[20:21], v7 offset:0
    ds_read_b64_tr_b16 v[22:23], v7 offset:512
    ds_read_b64_tr_b16 v[24:25], v8 offset:0
    ds_read_b64_tr_b16 v[26:27], v8 offset:512
    v_mfma_f32_32x32x16_bf16 v[64:79], v[36:39], v[156:159], v[64:79]
    ds_read_b64_tr_b16 v[28:29], v9 offset:0
    ds_read_b64_tr_b16 v[30:31], v9 offset:512
    v_mfma_f32_32x32x16_bf16 v[80:95], v[40:43], v[156:159], v[80:95]
    ds_read_b64_tr_b16 v[32:33], v6 offset:2048
    ds_read_b64_tr_b16 v[34:35], v6 offset:2560
    v_mfma_f32_32x32x16_bf16 v[96:111], v[44:47], v[156:159], v[96:111]
    ds_read_b64_tr_b16 v[36:37], v7 offset:2048
    ds_read_b64_tr_b16 v[38:39], v7 offset:2560
    s_waitcnt lgkmcnt(10)
    v_mfma_f32_32x32x16_bf16 v[48:63], v[16:19], v[160:163], v[48:63]
    ds_read_b64_tr_b16 v[40:41], v8 offset:2048
    ds_read_b64_tr_b16 v[42:43], v8 offset:2560
    s_waitcnt lgkmcnt(10)
    v_mfma_f32_32x32x16_bf16 v[64:79], v[20:23], v[160:163], v[64:79]
    ds_read_b64_tr_b16 v[44:45], v9 offset:2048
    ds_read_b64_tr_b16 v[46:47], v9 offset:2560
    s_waitcnt lgkmcnt(10)
    v_mfma_f32_32x32x16_bf16 v[80:95], v[24:27], v[160:163], v[80:95]
    ds_read_b64_tr_b16 v[16:17], v6 offset:4096
    ds_read_b64_tr_b16 v[18:19], v6 offset:4608
    s_waitcnt lgkmcnt(10)
    v_mfma_f32_32x32x16_bf16 v[96:111], v[28:31], v[160:163], v[96:111]
    ds_read_b64_tr_b16 v[20:21], v7 offset:4096
    ds_read_b64_tr_b16 v[22:23], v7 offset:4608
    s_waitcnt lgkmcnt(10)
    v_mfma_f32_32x32x16_bf16 v[48:63], v[32:35], v[164:167], v[48:63]
    ds_read_b64_tr_b16 v[24:25], v8 offset:4096
    ds_read_b64_tr_b16 v[26:27], v8 offset:4608
    s_waitcnt lgkmcnt(10)
    v_mfma_f32_32x32x16_bf16 v[64:79], v[36:39], v[164:167], v[64:79]
    ds_read_b64_tr_b16 v[28:29], v9 offset:4096
    ds_read_b64_tr_b16 v[30:31], v9 offset:4608
    s_waitcnt lgkmcnt(10)
    v_mfma_f32_32x32x16_bf16 v[80:95], v[40:43], v[164:167], v[80:95]
    ds_read_b64_tr_b16 v[32:33], v6 offset:6144
    ds_read_b64_tr_b16 v[34:35], v6 offset:6656
    s_waitcnt lgkmcnt(10)
    v_mfma_f32_32x32x16_bf16 v[96:111], v[44:47], v[164:167], v[96:111]
    ds_read_b64_tr_b16 v[36:37], v7 offset:6144
    ds_read_b64_tr_b16 v[38:39], v7 offset:6656
    s_waitcnt lgkmcnt(10)
    v_mfma_f32_32x32x16_bf16 v[48:63], v[16:19], v[168:171], v[48:63]
    ds_read_b64_tr_b16 v[40:41], v8 offset:6144
    ds_read_b64_tr_b16 v[42:43], v8 offset:6656
    s_waitcnt lgkmcnt(10)
    v_mfma_f32_32x32x16_bf16 v[64:79], v[20:23], v[168:171], v[64:79]
    ds_read_b64_tr_b16 v[44:45], v9 offset:6144
    ds_read_b64_tr_b16 v[46:47], v9 offset:6656
    s_waitcnt lgkmcnt(10)
    v_mfma_f32_32x32x16_bf16 v[80:95], v[24:27], v[168:171], v[80:95]
    ds_read_b64_tr_b16 v[16:17], v6 offset:16384
    ds_read_b64_tr_b16 v[18:19], v6 offset:16896
    s_waitcnt lgkmcnt(10)
    v_mfma_f32_32x32x16_bf16 v[96:111], v[28:31], v[168:171], v[96:111]
    ds_read_b64_tr_b16 v[20:21], v7 offset:16384
    ds_read_b64_tr_b16 v[22:23], v7 offset:16896
    s_waitcnt lgkmcnt(10)
    v_mfma_f32_32x32x16_bf16 v[48:63], v[32:35], v[172:175], v[48:63]
    ds_read_b64_tr_b16 v[24:25], v8 offset:16384
    ds_read_b64_tr_b16 v[26:27], v8 offset:16896
    s_waitcnt lgkmcnt(10)
    v_mfma_f32_32x32x16_bf16 v[64:79], v[36:39], v[172:175], v[64:79]
    ds_read_b64_tr_b16 v[28:29], v9 offset:16384
    ds_read_b64_tr_b16 v[30:31], v9 offset:16896
    s_waitcnt lgkmcnt(10)
    v_mfma_f32_32x32x16_bf16 v[80:95], v[40:43], v[172:175], v[80:95]
    ds_read_b64_tr_b16 v[32:33], v6 offset:18432
    ds_read_b64_tr_b16 v[34:35], v6 offset:18944
    s_waitcnt lgkmcnt(10)
    v_mfma_f32_32x32x16_bf16 v[96:111], v[44:47], v[172:175], v[96:111]
    ds_read_b64_tr_b16 v[36:37], v7 offset:18432
    ds_read_b64_tr_b16 v[38:39], v7 offset:18944
    s_waitcnt lgkmcnt(10)
    v_mfma_f32_32x32x16_bf16 v[48:63], v[16:19], v[176:179], v[48:63]
    ds_read_b64_tr_b16 v[40:41], v8 offset:18432
    ds_read_b64_tr_b16 v[42:43], v8 offset:18944
    s_waitcnt lgkmcnt(10)
    v_mfma_f32_32x32x16_bf16 v[64:79], v[20:23], v[176:179], v[64:79]
    ds_read_b64_tr_b16 v[44:45], v9 offset:18432
    ds_read_b64_tr_b16 v[46:47], v9 offset:18944
    s_waitcnt lgkmcnt(10)
    v_mfma_f32_32x32x16_bf16 v[80:95], v[24:27], v[176:179], v[80:95]
    ds_read_b64_tr_b16 v[16:17], v6 offset:20480
    ds_read_b64_tr_b16 v[18:19], v6 offset:20992
    s_waitcnt lgkmcnt(10)
    v_mfma_f32_32x32x16_bf16 v[96:111], v[28:31], v[176:179], v[96:111]
    ds_read_b64_tr_b16 v[20:21], v7 offset:20480
    ds_read_b64_tr_b16 v[22:23], v7 offset:20992
    s_waitcnt lgkmcnt(10)
    v_mfma_f32_32x32x16_bf16 v[48:63], v[32:35], v[180:183], v[48:63]
    ds_read_b64_tr_b16 v[24:25], v8 offset:20480
    ds_read_b64_tr_b16 v[26:27], v8 offset:20992
    s_waitcnt lgkmcnt(10)
    v_mfma_f32_32x32x16_bf16 v[64:79], v[36:39], v[180:183], v[64:79]
    ds_read_b64_tr_b16 v[28:29], v9 offset:20480
    ds_read_b64_tr_b16 v[30:31], v9 offset:20992
    s_waitcnt lgkmcnt(10)
    v_mfma_f32_32x32x16_bf16 v[80:95], v[40:43], v[180:183], v[80:95]
    ds_read_b64_tr_b16 v[32:33], v6 offset:22528
    ds_read_b64_tr_b16 v[34:35], v6 offset:23040
    s_waitcnt lgkmcnt(10)
    v_mfma_f32_32x32x16_bf16 v[96:111], v[44:47], v[180:183], v[96:111]
    ds_read_b64_tr_b16 v[36:37], v7 offset:22528
    ds_read_b64_tr_b16 v[38:39], v7 offset:23040
    s_waitcnt lgkmcnt(10)
    v_mfma_f32_32x32x16_bf16 v[48:63], v[16:19], v[184:187], v[48:63]
    ds_read_b64_tr_b16 v[40:41], v8 offset:22528
    ds_read_b64_tr_b16 v[42:43], v8 offset:23040
    s_waitcnt lgkmcnt(10)
    v_mfma_f32_32x32x16_bf16 v[64:79], v[20:23], v[184:187], v[64:79]
    ds_read_b64_tr_b16 v[44:45], v9 offset:22528
    ds_read_b64_tr_b16 v[46:47], v9 offset:23040
    s_waitcnt lgkmcnt(10)
    v_mfma_f32_32x32x16_bf16 v[80:95], v[24:27], v[184:187], v[80:95]
    s_waitcnt lgkmcnt(8)
    v_mfma_f32_32x32x16_bf16 v[96:111], v[28:31], v[184:187], v[96:111]
    s_waitcnt lgkmcnt(6)
    v_mfma_f32_32x32x16_bf16 v[48:63], v[32:35], v[188:191], v[48:63]
    s_waitcnt lgkmcnt(0)
    s_barrier
    ds_read_b64_tr_b16 v[16:17], v2 offset:0
    ds_read_b64_tr_b16 v[18:19], v2 offset:512
    ds_read_b64_tr_b16 v[20:21], v2 offset:2048
    ds_read_b64_tr_b16 v[22:23], v2 offset:2560
    ds_read_b64_tr_b16 v[24:25], v2 offset:4096
    ds_read_b64_tr_b16 v[26:27], v2 offset:4608
    v_mfma_f32_32x32x16_bf16 v[64:79], v[36:39], v[188:191], v[64:79]
    ds_read_b64_tr_b16 v[28:29], v2 offset:6144
    ds_read_b64_tr_b16 v[30:31], v2 offset:6656
    v_mfma_f32_32x32x16_bf16 v[80:95], v[40:43], v[188:191], v[80:95]
    ds_read_b64_tr_b16 v[32:33], v2 offset:16384
    ds_read_b64_tr_b16 v[34:35], v2 offset:16896
    v_mfma_f32_32x32x16_bf16 v[96:111], v[44:47], v[188:191], v[96:111]
    ds_read_b64_tr_b16 v[36:37], v2 offset:18432
    ds_read_b64_tr_b16 v[38:39], v2 offset:18944
    s_waitcnt lgkmcnt(10)
    v_mfma_f32_32x32x16_bf16 v[48:63], v[16:19], v[192:195], v[48:63]
    ds_read_b64_tr_b16 v[40:41], v2 offset:20480
    ds_read_b64_tr_b16 v[42:43], v2 offset:20992
    s_waitcnt lgkmcnt(10)
    v_mfma_f32_32x32x16_bf16 v[48:63], v[20:23], v[196:199], v[48:63]
    ds_read_b64_tr_b16 v[44:45], v2 offset:22528
    ds_read_b64_tr_b16 v[46:47], v2 offset:23040
    s_waitcnt lgkmcnt(10)
    v_mfma_f32_32x32x16_bf16 v[48:63], v[24:27], v[200:203], v[48:63]
    ds_read_b64_tr_b16 v[16:17], v3 offset:0
    ds_read_b64_tr_b16 v[18:19], v3 offset:512
    s_waitcnt lgkmcnt(10)
    v_mfma_f32_32x32x16_bf16 v[48:63], v[28:31], v[204:207], v[48:63]
    ds_read_b64_tr_b16 v[20:21], v3 offset:2048
    ds_read_b64_tr_b16 v[22:23], v3 offset:2560
    s_waitcnt lgkmcnt(10)
    v_mfma_f32_32x32x16_bf16 v[48:63], v[32:35], v[208:211], v[48:63]
    ds_read_b64_tr_b16 v[24:25], v3 offset:4096
    ds_read_b64_tr_b16 v[26:27], v3 offset:4608
    s_waitcnt lgkmcnt(10)
    v_mfma_f32_32x32x16_bf16 v[48:63], v[36:39], v[212:215], v[48:63]
    ds_read_b64_tr_b16 v[28:29], v3 offset:6144
    ds_read_b64_tr_b16 v[30:31], v3 offset:6656
    s_waitcnt lgkmcnt(10)
    v_mfma_f32_32x32x16_bf16 v[48:63], v[40:43], v[216:219], v[48:63]
    ds_read_b64_tr_b16 v[32:33], v3 offset:16384
    ds_read_b64_tr_b16 v[34:35], v3 offset:16896
    s_waitcnt lgkmcnt(10)
    v_mfma_f32_32x32x16_bf16 v[48:63], v[44:47], v[220:223], v[48:63]
    ds_read_b64_tr_b16 v[36:37], v3 offset:18432
    ds_read_b64_tr_b16 v[38:39], v3 offset:18944
    s_waitcnt lgkmcnt(10)
    v_mfma_f32_32x32x16_bf16 v[64:79], v[16:19], v[192:195], v[64:79]
    ds_read_b64_tr_b16 v[40:41], v3 offset:20480
    ds_read_b64_tr_b16 v[42:43], v3 offset:20992
    s_waitcnt lgkmcnt(10)
    v_mfma_f32_32x32x16_bf16 v[64:79], v[20:23], v[196:199], v[64:79]
    ds_read_b64_tr_b16 v[44:45], v3 offset:22528
    ds_read_b64_tr_b16 v[46:47], v3 offset:23040
    s_nop 1
    v_mul_f32 v48, v48, v56
    v_mul_f32 v49, v49, v57
    v_mul_f32 v50, v50, v58
    v_mul_f32 v51, v51, v59
    s_waitcnt lgkmcnt(10)
    v_mfma_f32_32x32x16_bf16 v[64:79], v[24:27], v[200:203], v[64:79]
    ds_read_b64_tr_b16 v[16:17], v4 offset:0
    ds_read_b64_tr_b16 v[18:19], v4 offset:512
    v_mul_f32 v52, v52, v60
    v_mul_f32 v53, v53, v61
    v_mul_f32 v54, v54, v62
    v_mul_f32 v55, v55, v63
    s_waitcnt lgkmcnt(10)
    v_mfma_f32_32x32x16_bf16 v[64:79], v[28:31], v[204:207], v[64:79]
    ds_read_b64_tr_b16 v[20:21], v4 offset:2048
    ds_read_b64_tr_b16 v[22:23], v4 offset:2560
    v_cvt_pk_bf16_f32 v240, v48, v49
    v_cvt_pk_bf16_f32 v241, v50, v51
    v_cvt_pk_bf16_f32 v242, v52, v53
    v_cvt_pk_bf16_f32 v243, v54, v55
    s_waitcnt lgkmcnt(10)
    v_mfma_f32_32x32x16_bf16 v[64:79], v[32:35], v[208:211], v[64:79]
    ds_read_b64_tr_b16 v[24:25], v4 offset:4096
    ds_read_b64_tr_b16 v[26:27], v4 offset:4608
    buffer_store_dwordx4 v[240:243], v1, s[40:43], s51 offen offset:0 sc1
    s_waitcnt lgkmcnt(10)
    v_mfma_f32_32x32x16_bf16 v[64:79], v[36:39], v[212:215], v[64:79]
    ds_read_b64_tr_b16 v[28:29], v4 offset:6144
    ds_read_b64_tr_b16 v[30:31], v4 offset:6656
    s_waitcnt lgkmcnt(10)
    v_mfma_f32_32x32x16_bf16 v[64:79], v[40:43], v[216:219], v[64:79]
    ds_read_b64_tr_b16 v[32:33], v4 offset:16384
    ds_read_b64_tr_b16 v[34:35], v4 offset:16896
    s_waitcnt lgkmcnt(10)
    v_mfma_f32_32x32x16_bf16 v[64:79], v[44:47], v[220:223], v[64:79]
    ds_read_b64_tr_b16 v[36:37], v4 offset:18432
    ds_read_b64_tr_b16 v[38:39], v4 offset:18944
    s_waitcnt lgkmcnt(10)
    v_mfma_f32_32x32x16_bf16 v[80:95], v[16:19], v[192:195], v[80:95]
    ds_read_b64_tr_b16 v[40:41], v4 offset:20480
    ds_read_b64_tr_b16 v[42:43], v4 offset:20992
    s_waitcnt lgkmcnt(10)
    v_mfma_f32_32x32x16_bf16 v[80:95], v[20:23], v[196:199], v[80:95]
    ds_read_b64_tr_b16 v[44:45], v4 offset:22528
    ds_read_b64_tr_b16 v[46:47], v4 offset:23040
    s_nop 1
    v_mul_f32 v64, v64, v72
    v_mul_f32 v65, v65, v73
    v_mul_f32 v66, v66, v74
    v_mul_f32 v67, v67, v75
    s_waitcnt lgkmcnt(10)
    v_mfma_f32_32x32x16_bf16 v[80:95], v[24:27], v[200:203], v[80:95]
    ds_read_b64_tr_b16 v[16:17], v5 offset:0
    ds_read_b64_tr_b16 v[18:19], v5 offset:512
    v_mul_f32 v68, v68, v76
    v_mul_f32 v69, v69, v77
    v_mul_f32 v70, v70, v78
    v_mul_f32 v71, v71, v79
    s_waitcnt lgkmcnt(10)
    v_mfma_f32_32x32x16_bf16 v[80:95], v[28:31], v[204:207], v[80:95]
    ds_read_b64_tr_b16 v[20:21], v5 offset:2048
    ds_read_b64_tr_b16 v[22:23], v5 offset:2560
    v_cvt_pk_bf16_f32 v244, v64, v65
    v_cvt_pk_bf16_f32 v245, v66, v67
    v_cvt_pk_bf16_f32 v246, v68, v69
    v_cvt_pk_bf16_f32 v247, v70, v71
    s_waitcnt lgkmcnt(10)
    v_mfma_f32_32x32x16_bf16 v[80:95], v[32:35], v[208:211], v[80:95]
    ds_read_b64_tr_b16 v[24:25], v5 offset:4096
    ds_read_b64_tr_b16 v[26:27], v5 offset:4608
    buffer_store_dwordx4 v[244:247], v1, s[40:43], s51 offen offset:1024 sc1
    s_waitcnt lgkmcnt(10)
    v_mfma_f32_32x32x16_bf16 v[80:95], v[36:39], v[212:215], v[80:95]
    ds_read_b64_tr_b16 v[28:29], v5 offset:6144
    ds_read_b64_tr_b16 v[30:31], v5 offset:6656
    s_waitcnt lgkmcnt(10)
    v_mfma_f32_32x32x16_bf16 v[80:95], v[40:43], v[216:219], v[80:95]
    ds_read_b64_tr_b16 v[32:33], v5 offset:16384
    ds_read_b64_tr_b16 v[34:35], v5 offset:16896
    s_waitcnt lgkmcnt(10)
    v_mfma_f32_32x32x16_bf16 v[80:95], v[44:47], v[220:223], v[80:95]
    ds_read_b64_tr_b16 v[36:37], v5 offset:18432
    ds_read_b64_tr_b16 v[38:39], v5 offset:18944
    s_waitcnt lgkmcnt(10)
    v_mfma_f32_32x32x16_bf16 v[96:111], v[16:19], v[192:195], v[96:111]
    ds_read_b64_tr_b16 v[40:41], v5 offset:20480
    ds_read_b64_tr_b16 v[42:43], v5 offset:20992
    s_waitcnt lgkmcnt(10)
    v_mfma_f32_32x32x16_bf16 v[96:111], v[20:23], v[196:199], v[96:111]
    ds_read_b64_tr_b16 v[44:45], v5 offset:22528
    ds_read_b64_tr_b16 v[46:47], v5 offset:23040
    s_nop 1
    v_mul_f32 v80, v80, v88
    v_mul_f32 v81, v81, v89
    v_mul_f32 v82, v82, v90
    v_mul_f32 v83, v83, v91
    s_waitcnt lgkmcnt(10)
    v_mfma_f32_32x32x16_bf16 v[96:111], v[24:27], v[200:203], v[96:111]
    v_mul_f32 v84, v84, v92
    v_mul_f32 v85, v85, v93
    v_mul_f32 v86, v86, v94
    v_mul_f32 v87, v87, v95
    v_cvt_pk_bf16_f32 v240, v80, v81
    v_cvt_pk_bf16_f32 v241, v82, v83
    s_waitcnt lgkmcnt(8)
    v_mfma_f32_32x32x16_bf16 v[96:111], v[28:31], v[204:207], v[96:111]
    v_cvt_pk_bf16_f32 v242, v84, v85
    v_cvt_pk_bf16_f32 v243, v86, v87
    buffer_store_dwordx4 v[240:243], v1, s[40:43], s51 offen offset:2048 sc1
    s_waitcnt lgkmcnt(6)
    v_mfma_f32_32x32x16_bf16 v[96:111], v[32:35], v[208:211], v[96:111]
    s_waitcnt lgkmcnt(4)
    v_mfma_f32_32x32x16_bf16 v[96:111], v[36:39], v[212:215], v[96:111]
    s_waitcnt lgkmcnt(2)
    v_mfma_f32_32x32x16_bf16 v[96:111], v[40:43], v[216:219], v[96:111]
    s_waitcnt lgkmcnt(0)
    v_mfma_f32_32x32x16_bf16 v[96:111], v[44:47], v[220:223], v[96:111]
    s_nop 11
    v_mul_f32 v96, v96, v104
    v_mul_f32 v97, v97, v105
    v_mul_f32 v98, v98, v106
    v_mul_f32 v99, v99, v107
    v_mul_f32 v100, v100, v108
    v_mul_f32 v101, v101, v109
    v_mul_f32 v102, v102, v110
    v_mul_f32 v103, v103, v111
    v_cvt_pk_bf16_f32 v244, v96, v97
    v_cvt_pk_bf16_f32 v245, v98, v99
    v_cvt_pk_bf16_f32 v246, v100, v101
    v_cvt_pk_bf16_f32 v247, v102, v103
    buffer_store_dwordx4 v[244:247], v1, s[40:43], s51 offen offset:3072 sc1
    s_setprio 0
    s_bfe_u32 s70, s7, 0x80008
    s_mul_i32 s70, s70, 28672
    s_lshl1_add_u32 m0, s64, 49152
    s_add_u32 s70, s70, 802816
    buffer_load_dwordx4 v230, s[36:39], s70 offen offset:0 lds
    s_add_u32 s70, s70, 6144
    buffer_load_dwordx4 v230, s[36:39], s70 offen offset:1024 lds
    s_add_u32 s70, s70, 6144
    buffer_load_dwordx4 v230, s[36:39], s70 offen offset:2048 lds
    s_add_u32 s70, s70, 6144
    buffer_load_dwordx4 v230, s[36:39], s70 offen offset:3072 lds
    ds_read_b64_tr_b16 v[16:17], v236 offset:32768
    ds_read_b64_tr_b16 v[18:19], v236 offset:33792
    ds_read_b64_tr_b16 v[20:21], v237 offset:32768
    ds_read_b64_tr_b16 v[22:23], v237 offset:33792
    ds_read_b64_tr_b16 v[24:25], v236 offset:34816
    ds_read_b64_tr_b16 v[26:27], v236 offset:35840
    ds_read_b64_tr_b16 v[28:29], v237 offset:34816
    ds_read_b64_tr_b16 v[30:31], v237 offset:35840
    v_lshrrev_b32 v2, 5, v1
    v_and_b32 v2, 16, v2
    v_xor_b32 v2, v2, v1
    s_lshl1_add_u32 s66, s64, 114688
    v_add_u32 v2, s66, v2
    v_xor_b32 v3, 32, v2
    v_xor_b32 v4, 64, v2
    v_xor_b32 v5, 96, v2
    ds_read_b64_tr_b16 v[32:33], v236 offset:49152
    ds_read_b64_tr_b16 v[34:35], v236 offset:50176
    ds_read_b64_tr_b16 v[36:37], v237 offset:49152
    ds_read_b64_tr_b16 v[38:39], v237 offset:50176
    ds_read_b64_tr_b16 v[40:41], v236 offset:51200
    ds_read_b64_tr_b16 v[42:43], v236 offset:52224
    ds_read_b64_tr_b16 v[44:45], v237 offset:51200
    ds_read_b64_tr_b16 v[46:47], v237 offset:52224
    s_waitcnt lgkmcnt(0)
    s_barrier
    s_bfe_u32 s70, s6, 0x80000
    s_lshl_b32 s70, s70, 11
    s_add_u32 s70, s70, s62
    s_add_u32 s70, s70, 57344
    buffer_load_dwordx4 v[112:115], v1, s[40:43], s70 offen offset:0 sc1
    buffer_load_dwordx4 v[120:123], v1, s[40:43], s70 offen offset:1024 sc1
    s_add_u32 s70, s70, 114688
    buffer_load_dwordx4 v[116:119], v1, s[40:43], s70 offen offset:0 sc1
    buffer_load_dwordx4 v[124:127], v1, s[40:43], s70 offen offset:1024 sc1
    s_bfe_u32 s70, s6, 0x80008
    s_lshl_b32 s70, s70, 11
    s_add_u32 s70, s70, s62
    s_add_u32 s70, s70, 57344
    buffer_load_dwordx4 v[128:131], v1, s[40:43], s70 offen offset:0 sc1
    buffer_load_dwordx4 v[136:139], v1, s[40:43], s70 offen offset:1024 sc1
    s_add_u32 s70, s70, 114688
    buffer_load_dwordx4 v[132:135], v1, s[40:43], s70 offen offset:0 sc1
    buffer_load_dwordx4 v[140:143], v1, s[40:43], s70 offen offset:1024 sc1
    s_bfe_u32 s70, s6, 0x80010
    s_lshl_b32 s70, s70, 11
    s_add_u32 s70, s70, s62
    s_add_u32 s70, s70, 57344
    buffer_load_dwordx4 v[144:147], v1, s[40:43], s70 offen offset:0 sc1
    buffer_load_dwordx4 v[152:155], v1, s[40:43], s70 offen offset:1024 sc1
    s_add_u32 s70, s70, 114688
    buffer_load_dwordx4 v[148:151], v1, s[40:43], s70 offen offset:0 sc1
    buffer_load_dwordx4 v[156:159], v1, s[40:43], s70 offen offset:1024 sc1
    s_add_u32 s72, s11, 1835008
    s_mov_b64 s[44:45], s[18:19]
    s_mov_b32 s46, 0x1c0000
    s_mov_b32 s47, 0x20000
    s_mov_b64 s[24:25], s[4:5]
    s_mov_b32 s26, 0x1c0000
    s_mov_b32 s27, 0x20000
    s_and_b32 s9, s60, 0x39
    s_lshl2_add_u32 s9, s56, s9
    s_mul_i32 s9, s9, 896
    s_lshl_b32 s67, s57, 7
    s_add_u32 s9, s9, s67
    s_mul_i32 s66, s53, 12
    s_and_b32 s66, s66, 0x14
    s_cmp_eq_u32 s53, 3
    s_cselect_b32 s66, 0x14, s66
    v_bfe_u32 v249, v1, 7, 1
    v_bfe_u32 v250, v1, 8, 1
    v_lshl_add_u32 v249, v250, 3, v249
    v_lshrrev_b32 v250, 9, v1
    v_lshl_add_u32 v249, v250, 1, v249
    v_add_u32 v249, s66, v249
    v_mul_u32_u24 v248, 57344, v249
    v_and_b32 v250, 0x70, v1
    v_add_u32 v248, v248, v250
    v_lshlrev_b32 v249, 4, v249
    buffer_load_dwordx4 v[240:243], v248, s[24:27], s9 offen offset:0
    v_bfe_u32 v250, v1, 6, 1
    v_lshlrev_b32 v250, 14, v250
    v_and_b32 v15, 0x30, v1
    v_lshl_add_u32 v250, v15, 6, v250
    v_lshlrev_b32 v15, 1, v15
    v_xor_b32 v15, v15, v249
    v_add_u32 v250, v250, v15
    v_xor_b32 v251, 528, v250
    v_add_u32 v252, 81920, v250
    v_add_u32 v253, 81920, v251
    s_waitcnt vmcnt(10)
    v_max3_u32 v15, v115, v119, v123
    s_waitcnt vmcnt(9)
    v_max_u32 v15, v15, v127
    v_cmp_eq_u32 vcc, -1, v15
    s_cbranch_vccnz spin_2
ok_1:
    v_mfma_f32_32x32x16_bf16 v[48:63], v[16:19], v[112:115], 0
    v_mfma_f32_32x32x16_bf16 v[80:95], v[16:19], v[116:119], 0
    ds_read_b64_tr_b16 v[16:17], v238 offset:0
    ds_read_b64_tr_b16 v[18:19], v238 offset:1024
    v_mfma_f32_32x32x16_bf16 v[64:79], v[20:23], v[112:115], 0
    v_mfma_f32_32x32x16_bf16 v[96:111], v[20:23], v[116:119], 0
    ds_read_b64_tr_b16 v[20:21], v239 offset:0
    ds_read_b64_tr_b16 v[22:23], v239 offset:1024
    v_mfma_f32_32x32x16_bf16 v[48:63], v[24:27], v[120:123], v[48:63]
    v_mfma_f32_32x32x16_bf16 v[80:95], v[24:27], v[124:127], v[80:95]
    ds_read_b64_tr_b16 v[24:25], v238 offset:2048
    ds_read_b64_tr_b16 v[26:27], v238 offset:3072
    v_mfma_f32_32x32x16_bf16 v[64:79], v[28:31], v[120:123], v[64:79]
    v_mfma_f32_32x32x16_bf16 v[96:111], v[28:31], v[124:127], v[96:111]
    ds_read_b64_tr_b16 v[28:29], v239 offset:2048
    ds_read_b64_tr_b16 v[30:31], v239 offset:3072
    s_bfe_u32 s70, s6, 0x80018
    s_lshl_b32 s70, s70, 11
    s_add_u32 s70, s70, s62
    s_add_u32 s70, s70, 57344
    buffer_load_dwordx4 v[160:163], v1, s[40:43], s70 offen offset:0 sc1
    buffer_load_dwordx4 v[168:171], v1, s[40:43], s70 offen offset:1024 sc1
    s_add_u32 s70, s70, 114688
    buffer_load_dwordx4 v[164:167], v1, s[40:43], s70 offen offset:0 sc1
    buffer_load_dwordx4 v[172:175], v1, s[40:43], s70 offen offset:1024 sc1
    s_waitcnt vmcnt(10)
    v_max3_u32 v15, v131, v135, v139
    s_waitcnt vmcnt(9)
    v_max_u32 v15, v15, v143
    v_cmp_eq_u32 vcc, -1, v15
    s_cbranch_vccnz spin_4
ok_3:
    v_mfma_f32_32x32x16_bf16 v[48:63], v[32:35], v[128:131], v[48:63]
    v_mfma_f32_32x32x16_bf16 v[80:95], v[32:35], v[132:135], v[80:95]
    ds_read_b64_tr_b16 v[32:33], v238 offset:16384
    ds_read_b64_tr_b16 v[34:35], v238 offset:17408
    v_mfma_f32_32x32x16_bf16 v[64:79], v[36:39], v[128:131], v[64:79]
    v_mfma_f32_32x32x16_bf16 v[96:111], v[36:39], v[132:135], v[96:111]
    ds_read_b64_tr_b16 v[36:37], v239 offset:16384
    ds_read_b64_tr_b16 v[38:39], v239 offset:17408
    v_mfma_f32_32x32x16_bf16 v[48:63], v[40:43], v[136:139], v[48:63]
    v_mfma_f32_32x32x16_bf16 v[80:95], v[40:43], v[140:143], v[80:95]
    ds_read_b64_tr_b16 v[40:41], v238 offset:18432
    ds_read_b64_tr_b16 v[42:43], v238 offset:19456
    v_mfma_f32_32x32x16_bf16 v[64:79], v[44:47], v[136:139], v[64:79]
    v_mfma_f32_32x32x16_bf16 v[96:111], v[44:47], v[140:143], v[96:111]
    ds_read_b64_tr_b16 v[44:45], v239 offset:18432
    ds_read_b64_tr_b16 v[46:47], v239 offset:19456
    s_bfe_u32 s70, s7, 0x80000
    s_lshl_b32 s70, s70, 11
    s_add_u32 s70, s70, s62
    s_add_u32 s70, s70, 57344
    buffer_load_dwordx4 v[176:179], v1, s[40:43], s70 offen offset:0 sc1
    buffer_load_dwordx4 v[184:187], v1, s[40:43], s70 offen offset:1024 sc1
    s_add_u32 s70, s70, 114688
    buffer_load_dwordx4 v[180:183], v1, s[40:43], s70 offen offset:0 sc1
    buffer_load_dwordx4 v[188:191], v1, s[40:43], s70 offen offset:1024 sc1
    s_bfe_u32 s70, s7, 0x80010
    s_mul_i32 s70, s70, 28672
    s_lshl1_add_u32 m0, s64, 65536
    s_add_u32 s70, s70, 802816
    buffer_load_dwordx4 v230, s[36:39], s70 offen offset:0 lds
    s_add_u32 s70, s70, 6144
    buffer_load_dwordx4 v230, s[36:39], s70 offen offset:1024 lds
    s_add_u32 s70, s70, 6144
    buffer_load_dwordx4 v230, s[36:39], s70 offen offset:2048 lds
    s_add_u32 s70, s70, 6144
    buffer_load_dwordx4 v230, s[36:39], s70 offen offset:3072 lds
    s_bfe_u32 s70, s7, 0x80008
    s_lshl_b32 s70, s70, 11
    s_add_u32 s70, s70, s62
    s_add_u32 s70, s70, 57344
    buffer_load_dwordx4 v[192:195], v1, s[40:43], s70 offen offset:0 sc1
    buffer_load_dwordx4 v[200:203], v1, s[40:43], s70 offen offset:1024 sc1
    s_add_u32 s70, s70, 114688
    buffer_load_dwordx4 v[196:199], v1, s[40:43], s70 offen offset:0 sc1
    buffer_load_dwordx4 v[204:207], v1, s[40:43], s70 offen offset:1024 sc1
    s_bfe_u32 s70, s7, 0x80010
    s_lshl_b32 s70, s70, 11
    s_add_u32 s70, s70, s62
    s_add_u32 s70, s70, 57344
    buffer_load_dwordx4 v[208:211], v1, s[40:43], s70 offen offset:0 sc1
    buffer_load_dwordx4 v[216:219], v1, s[40:43], s70 offen offset:1024 sc1
    s_add_u32 s70, s70, 114688
    buffer_load_dwordx4 v[212:215], v1, s[40:43], s70 offen offset:0 sc1
    buffer_load_dwordx4 v[220:223], v1, s[40:43], s70 offen offset:1024 sc1
    s_setprio 2
    s_waitcnt vmcnt(22)
    v_max3_u32 v15, v147, v151, v155
    s_waitcnt vmcnt(21)
    v_max_u32 v15, v15, v159
    v_cmp_eq_u32 vcc, -1, v15
    s_cbranch_vccnz spin_6
ok_5:
    s_waitcnt lgkmcnt(14)
    v_mfma_f32_32x32x16_bf16 v[48:63], v[16:19], v[144:147], v[48:63]
    v_mfma_f32_32x32x16_bf16 v[80:95], v[16:19], v[148:151], v[80:95]
    ds_read_b64_tr_b16 v[16:17], v234 offset:32768
    ds_read_b64_tr_b16 v[18:19], v234 offset:33792
    s_waitcnt lgkmcnt(14)
    v_mfma_f32_32x32x16_bf16 v[64:79], v[20:23], v[144:147], v[64:79]
    v_mfma_f32_32x32x16_bf16 v[96:111], v[20:23], v[148:151], v[96:111]
    ds_read_b64_tr_b16 v[20:21], v235 offset:32768
    ds_read_b64_tr_b16 v[22:23], v235 offset:33792
    s_waitcnt lgkmcnt(14)
    v_mfma_f32_32x32x16_bf16 v[48:63], v[24:27], v[152:155], v[48:63]
    v_mfma_f32_32x32x16_bf16 v[80:95], v[24:27], v[156:159], v[80:95]
    ds_read_b64_tr_b16 v[24:25], v234 offset:34816
    ds_read_b64_tr_b16 v[26:27], v234 offset:35840
    s_waitcnt lgkmcnt(14)
    v_mfma_f32_32x32x16_bf16 v[64:79], v[28:31], v[152:155], v[64:79]
    v_mfma_f32_32x32x16_bf16 v[96:111], v[28:31], v[156:159], v[96:111]
    ds_read_b64_tr_b16 v[28:29], v235 offset:34816
    ds_read_b64_tr_b16 v[30:31], v235 offset:35840
    s_waitcnt vmcnt(17)
    v_max3_u32 v15, v163, v167, v171
    s_waitcnt vmcnt(16)
    v_max_u32 v15, v15, v175
    v_cmp_eq_u32 vcc, -1, v15
    s_cbranch_vccnz spin_8
ok_7:
    s_waitcnt lgkmcnt(14)
    v_mfma_f32_32x32x16_bf16 v[48:63], v[32:35], v[160:163], v[48:63]
    v_mfma_f32_32x32x16_bf16 v[80:95], v[32:35], v[164:167], v[80:95]
    ds_read_b64_tr_b16 v[32:33], v234 offset:49152
    ds_read_b64_tr_b16 v[34:35], v234 offset:50176
    s_waitcnt lgkmcnt(14)
    v_mfma_f32_32x32x16_bf16 v[64:79], v[36:39], v[160:163], v[64:79]
    v_mfma_f32_32x32x16_bf16 v[96:111], v[36:39], v[164:167], v[96:111]
    ds_read_b64_tr_b16 v[36:37], v235 offset:49152
    ds_read_b64_tr_b16 v[38:39], v235 offset:50176
    s_waitcnt lgkmcnt(14)
    v_mfma_f32_32x32x16_bf16 v[48:63], v[40:43], v[168:171], v[48:63]
    v_mfma_f32_32x32x16_bf16 v[80:95], v[40:43], v[172:175], v[80:95]
    ds_read_b64_tr_b16 v[40:41], v234 offset:51200
    ds_read_b64_tr_b16 v[42:43], v234 offset:52224
    s_waitcnt lgkmcnt(14)
    v_mfma_f32_32x32x16_bf16 v[64:79], v[44:47], v[168:171], v[64:79]
    v_mfma_f32_32x32x16_bf16 v[96:111], v[44:47], v[172:175], v[96:111]
    ds_read_b64_tr_b16 v[44:45], v235 offset:51200
    ds_read_b64_tr_b16 v[46:47], v235 offset:52224
    buffer_load_dword v244, v249, s[40:43], s72 offen offset:0 sc1
    s_waitcnt vmcnt(14)
    v_max3_u32 v15, v179, v183, v187
    s_waitcnt vmcnt(13)
    v_max_u32 v15, v15, v191
    v_cmp_eq_u32 vcc, -1, v15
    s_cbranch_vccnz spin_10
ok_9:
    s_waitcnt lgkmcnt(14)
    v_mfma_f32_32x32x16_bf16 v[48:63], v[16:19], v[176:179], v[48:63]
    v_mfma_f32_32x32x16_bf16 v[80:95], v[16:19], v[180:183], v[80:95]
    s_waitcnt vmcnt(9)
    ds_read_b64_tr_b16 v[16:17], v236 offset:0
    ds_read_b64_tr_b16 v[18:19], v236 offset:1024
    s_waitcnt lgkmcnt(14)
    v_mfma_f32_32x32x16_bf16 v[64:79], v[20:23], v[176:179], v[64:79]
    v_mfma_f32_32x32x16_bf16 v[96:111], v[20:23], v[180:183], v[96:111]
    ds_read_b64_tr_b16 v[20:21], v237 offset:0
    ds_read_b64_tr_b16 v[22:23], v237 offset:1024
    s_waitcnt lgkmcnt(14)
    v_mfma_f32_32x32x16_bf16 v[48:63], v[24:27], v[184:187], v[48:63]
    v_mfma_f32_32x32x16_bf16 v[80:95], v[24:27], v[188:191], v[80:95]
    ds_read_b64_tr_b16 v[24:25], v236 offset:2048
    ds_read_b64_tr_b16 v[26:27], v236 offset:3072
    s_waitcnt lgkmcnt(14)
    v_mfma_f32_32x32x16_bf16 v[64:79], v[28:31], v[184:187], v[64:79]
    v_mfma_f32_32x32x16_bf16 v[96:111], v[28:31], v[188:191], v[96:111]
    ds_read_b64_tr_b16 v[28:29], v237 offset:2048
    ds_read_b64_tr_b16 v[30:31], v237 offset:3072
    s_waitcnt vmcnt(6)
    v_max3_u32 v15, v195, v199, v203
    s_waitcnt vmcnt(5)
    v_max_u32 v15, v15, v207
    v_cmp_eq_u32 vcc, -1, v15
    s_cbranch_vccnz spin_12
ok_11:
    s_waitcnt vmcnt(2)
    v_max3_u32 v15, v211, v215, v219
    s_waitcnt vmcnt(1)
    v_max_u32 v15, v15, v223
    v_cmp_eq_u32 vcc, -1, v15
    s_cbranch_vccnz spin_14
ok_13:
    s_waitcnt lgkmcnt(14)
    v_mfma_f32_32x32x16_bf16 v[48:63], v[32:35], v[192:195], v[48:63]
    v_lshlrev_b32 v180, 16, v242
    v_and_b32 v181, 0xffff0000, v242
    v_lshlrev_b32 v182, 16, v243
    v_and_b32 v183, 0xffff0000, v243
    v_lshlrev_b32 v176, 16, v240
    s_waitcnt lgkmcnt(10)
    v_mfma_f32_32x32x16_bf16 v[48:63], v[40:43], v[200:203], v[48:63]
    v_and_b32 v177, 0xffff0000, v240
    v_lshlrev_b32 v178, 16, v241
    v_and_b32 v179, 0xffff0000, v241
    s_waitcnt lgkmcnt(6)
    v_mfma_f32_32x32x16_bf16 v[48:63], v[16:19], v[208:211], v[48:63]
    s_waitcnt lgkmcnt(2)
    v_mfma_f32_32x32x16_bf16 v[48:63], v[24:27], v[216:219], v[48:63]
    v_mfma_f32_32x32x16_bf16 v[64:79], v[36:39], v[192:195], v[64:79]
    v_mfma_f32_32x32x16_bf16 v[64:79], v[44:47], v[200:203], v[64:79]
    s_nop 9
    ds_write_b128 v2, v[48:51] offset:0
    ds_write_b128 v3, v[52:55] offset:1024
    v_mfma_f32_32x32x16_bf16 v[64:79], v[20:23], v[208:211], v[64:79]
    ds_write_b128 v4, v[56:59] offset:2048
    ds_write_b128 v5, v[60:63] offset:3072
    s_waitcnt lgkmcnt(4)
    v_mfma_f32_32x32x16_bf16 v[64:79], v[28:31], v[216:219], v[64:79]
    v_mfma_f32_32x32x16_bf16 v[80:95], v[32:35], v[196:199], v[80:95]
    v_mfma_f32_32x32x16_bf16 v[80:95], v[40:43], v[204:207], v[80:95]
    s_nop 9
    ds_write_b128 v2, v[64:67] offset:16384
    v_add_u32 v2, -81920, v2
    ds_write_b128 v3, v[68:71] offset:17408
    v_mfma_f32_32x32x16_bf16 v[80:95], v[16:19], v[212:215], v[80:95]
    v_add_u32 v3, -81920, v3
    ds_write_b128 v4, v[72:75] offset:18432
    v_add_u32 v4, -81920, v4
    ds_write_b128 v5, v[76:79] offset:19456
    v_mfma_f32_32x32x16_bf16 v[80:95], v[24:27], v[220:223], v[80:95]
    v_add_u32 v5, -81920, v5
    v_mfma_f32_32x32x16_bf16 v[96:111], v[36:39], v[196:199], v[96:111]
    v_mfma_f32_32x32x16_bf16 v[96:111], v[44:47], v[204:207], v[96:111]
    s_nop 8
    ds_write_b128 v2, v[80:83] offset:0
    ds_write_b128 v3, v[84:87] offset:1024
    v_mfma_f32_32x32x16_bf16 v[96:111], v[20:23], v[212:215], v[96:111]
    ds_write_b128 v4, v[88:91] offset:2048
    ds_write_b128 v5, v[92:95] offset:3072
    v_mfma_f32_32x32x16_bf16 v[96:111], v[28:31], v[220:223], v[96:111]
    s_nop 11
    ds_write_b128 v2, v[96:99] offset:16384
    ds_write_b128 v3, v[100:103] offset:17408
    ds_write_b128 v4, v[104:107] offset:18432
    ds_write_b128 v5, v[108:111] offset:19456
    s_waitcnt vmcnt(0)
    v_cmp_eq_u32 vcc, -1, v244
    s_cbranch_vccnz spin_16
ok_15:
    v_lshlrev_b32 v244, 16, v244
    v_fma_f32 v176, v244, 0.5, v176
    v_fma_f32 v177, v244, -0.5, v177
    v_fma_f32 v178, v244, 0.5, v178
    v_fma_f32 v179, v244, -0.5, v179
    v_fma_f32 v180, v244, 0.5, v180
    v_fma_f32 v181, v244, -0.5, v181
    v_fma_f32 v182, v244, 0.5, v182
    v_fma_f32 v183, v244, -0.5, v183
    s_waitcnt lgkmcnt(0)
    s_barrier
    s_setprio 0
    ds_read_b128 v[112:115], v252 offset:32768
    ds_read_b128 v[116:119], v252 offset:36864
    ds_read_b128 v[120:123], v252 offset:40960
    ds_read_b128 v[124:127], v252 offset:45056
    ds_read_b128 v[128:131], v250 offset:0
    ds_read_b128 v[132:135], v250 offset:4096
    ds_read_b128 v[136:139], v250 offset:8192
    ds_read_b128 v[140:143], v250 offset:12288
    ds_read_b128 v[144:147], v253 offset:32768
    ds_read_b128 v[148:151], v253 offset:36864
    ds_read_b128 v[152:155], v253 offset:40960
    ds_read_b128 v[156:159], v253 offset:45056
    ds_read_b128 v[160:163], v251 offset:0
    ds_read_b128 v[164:167], v251 offset:4096
    ds_read_b128 v[168:171], v251 offset:8192
    ds_read_b128 v[172:175], v251 offset:12288
    s_waitcnt lgkmcnt(14)
    v_pk_add_f32 v[112:113], v[112:113], v[116:117]
    v_pk_add_f32 v[114:115], v[114:115], v[118:119]
    v_pk_add_f32 v[176:177], v[176:177], v[112:113]
    v_pk_add_f32 v[178:179], v[178:179], v[114:115]
    s_waitcnt lgkmcnt(12)
    v_pk_add_f32 v[120:121], v[120:121], v[124:125]
    v_pk_add_f32 v[122:123], v[122:123], v[126:127]
    v_pk_add_f32 v[176:177], v[176:177], v[120:121]
    v_pk_add_f32 v[178:179], v[178:179], v[122:123]
    s_waitcnt lgkmcnt(10)
    v_pk_add_f32 v[128:129], v[128:129], v[132:133]
    v_pk_add_f32 v[130:131], v[130:131], v[134:135]
    v_pk_add_f32 v[176:177], v[176:177], v[128:129]
    v_pk_add_f32 v[178:179], v[178:179], v[130:131]
    s_waitcnt lgkmcnt(8)
    v_pk_add_f32 v[136:137], v[136:137], v[140:141]
    v_pk_add_f32 v[138:139], v[138:139], v[142:143]
    v_pk_add_f32 v[176:177], v[176:177], v[136:137]
    v_pk_add_f32 v[178:179], v[178:179], v[138:139]
    v_cvt_pk_bf16_f32 v176, v176, v177
    v_cvt_pk_bf16_f32 v177, v178, v179
    s_waitcnt lgkmcnt(6)
    v_pk_add_f32 v[144:145], v[144:145], v[148:149]
    v_pk_add_f32 v[146:147], v[146:147], v[150:151]
    v_pk_add_f32 v[180:181], v[180:181], v[144:145]
    v_pk_add_f32 v[182:183], v[182:183], v[146:147]
    s_waitcnt lgkmcnt(4)
    v_pk_add_f32 v[152:153], v[152:153], v[156:157]
    v_pk_add_f32 v[154:155], v[154:155], v[158:159]
    v_pk_add_f32 v[180:181], v[180:181], v[152:153]
    v_pk_add_f32 v[182:183], v[182:183], v[154:155]
    s_waitcnt lgkmcnt(2)
    v_pk_add_f32 v[160:161], v[160:161], v[164:165]
    v_pk_add_f32 v[162:163], v[162:163], v[166:167]
    v_pk_add_f32 v[180:181], v[180:181], v[160:161]
    v_pk_add_f32 v[182:183], v[182:183], v[162:163]
    s_waitcnt lgkmcnt(0)
    v_pk_add_f32 v[168:169], v[168:169], v[172:173]
    v_pk_add_f32 v[170:171], v[170:171], v[174:175]
    v_pk_add_f32 v[180:181], v[180:181], v[168:169]
    v_pk_add_f32 v[182:183], v[182:183], v[170:171]
    v_cvt_pk_bf16_f32 v178, v180, v181
    v_cvt_pk_bf16_f32 v179, v182, v183
    buffer_store_dwordx4 v[176:179], v248, s[44:47], s9 offen offset:0 sc1
    s_endpgm
G_R1:
    s_lshl_b32 s3, s55, 7
    s_add_u32 s3, s3, s61
    s_lshl_b32 s3, s3, 10
    s_waitcnt lgkmcnt(0)
    s_mov_b64 s[40:41], s[22:23]
    s_mov_b32 s42, 0xdd0000
    s_mov_b32 s43, 0x20000
    s_add_u32 s72, s22, 0x430000
    s_addc_u32 s73, s23, 0
    s_load_dword s59, s[72:73], 8
    v_bfe_u32 v240, v1, 5, 4
    s_lshl_b32 s66, s55, 4
    v_add_u32 v240, s66, v240
    v_bfe_u32 v241, v1, 4, 1
    v_lshl_add_u32 v242, v240, 1, v241
    v_cmp_eq_u32 vcc, 1, v242
    v_mov_b32 v243, 224
    v_cvt_f32_u32 v241, v241
    v_cndmask_b32 v240, v240, v243, vcc
    v_mul_f32 v241, 0x3e800000, v241
    v_cvt_f32_u32 v240, v240
    v_cndmask_b32 v241, v241, 0, vcc
    v_mul_f32 v240, 0x3b124925, v240
    v_lshrrev_b32 v242, 9, v1
    v_lshlrev_b32 v242, 3, v242
    s_xor_b32 s67, s52, 0
    s_bfe_u32 s66, s58, 0x40000
    s_lshl_b32 s66, s66, 2
    s_add_u32 s66, s66, s67
    s_lshl_b32 s66, s66, 4
    s_sub_u32 s66, s66, 448
    v_add_u32 v242, s66, v242
    v_cvt_f32_i32 v242, v242
    v_fmac_f32 v241, v240, v242
    s_lshl_b32 s67, s67, 10
    s_add_u32 s67, s67, 131072
    v_add_u32 v243, s67, v1
    v_mov_b32 v242, 0
    s_mov_b32 s66, 0x3f803f80
    v_fmamk_f32 v145, v240, 0x3f800000, v241
    v_fmamk_f32 v146, v240, 0x40000000, v241
    v_fmamk_f32 v147, v240, 0x40400000, v241
    v_fmamk_f32 v148, v240, 0x40800000, v241
    v_fmamk_f32 v149, v240, 0x40a00000, v241
    v_fmamk_f32 v150, v240, 0x40c00000, v241
    v_fmamk_f32 v151, v240, 0x40e00000, v241
    v_cos_f32 v144, v241
    v_cos_f32 v145, v145
    v_cos_f32 v146, v146
    v_cos_f32 v147, v147
    v_cos_f32 v148, v148
    v_cos_f32 v149, v149
    v_cos_f32 v150, v150
    v_cos_f32 v151, v151
    v_cvt_pk_bf16_f32 v160, v144, v145
    v_cvt_pk_bf16_f32 v161, v146, v147
    v_cvt_pk_bf16_f32 v162, v148, v149
    v_cvt_pk_bf16_f32 v163, v150, v151
    ds_write_b128 v243, v[160:163] offset:0
    v_dot2c_f32_bf16 v242, s66, v160
    v_dot2c_f32_bf16 v242, s66, v161
    v_dot2c_f32_bf16 v242, s66, v162
    v_dot2c_f32_bf16 v242, s66, v163
    v_fmamk_f32 v152, v240, 0x43000000, v241
    v_fmamk_f32 v153, v240, 0x43010000, v241
    v_fmamk_f32 v154, v240, 0x43020000, v241
    v_fmamk_f32 v155, v240, 0x43030000, v241
    v_fmamk_f32 v156, v240, 0x43040000, v241
    v_fmamk_f32 v157, v240, 0x43050000, v241
    v_fmamk_f32 v158, v240, 0x43060000, v241
    v_fmamk_f32 v159, v240, 0x43070000, v241
    v_cos_f32 v152, v152
    v_cos_f32 v153, v153
    v_cos_f32 v154, v154
    v_cos_f32 v155, v155
    v_cos_f32 v156, v156
    v_cos_f32 v157, v157
    v_cos_f32 v158, v158
    v_cos_f32 v159, v159
    v_cvt_pk_bf16_f32 v164, v152, v153
    v_cvt_pk_bf16_f32 v165, v154, v155
    v_cvt_pk_bf16_f32 v166, v156, v157
    v_cvt_pk_bf16_f32 v167, v158, v159
    ds_write_b128 v243, v[164:167] offset:8192
    v_dot2c_f32_bf16 v242, s66, v164
    v_dot2c_f32_bf16 v242, s66, v165
    v_dot2c_f32_bf16 v242, s66, v166
    v_dot2c_f32_bf16 v242, s66, v167
    v_fmamk_f32 v144, v240, 0x43800000, v241
    v_fmamk_f32 v145, v240, 0x43808000, v241
    v_fmamk_f32 v146, v240, 0x43810000, v241
    v_fmamk_f32 v147, v240, 0x43818000, v241
    v_fmamk_f32 v148, v240, 0x43820000, v241
    v_fmamk_f32 v149, v240, 0x43828000, v241
    v_fmamk_f32 v150, v240, 0x43830000, v241
    v_fmamk_f32 v151, v240, 0x43838000, v241
    v_cos_f32 v144, v144
    v_cos_f32 v145, v145
    v_cos_f32 v146, v146
    v_cos_f32 v147, v147
    v_cos_f32 v148, v148
    v_cos_f32 v149, v149
    v_cos_f32 v150, v150
    v_cos_f32 v151, v151
    v_cvt_pk_bf16_f32 v160, v144, v145
    v_cvt_pk_bf16_f32 v161, v146, v147
    v_cvt_pk_bf16_f32 v162, v148, v149
    v_cvt_pk_bf16_f32 v163, v150, v151
    ds_write_b128 v243, v[160:163] offset:16384
    v_dot2c_f32_bf16 v242, s66, v160
    v_dot2c_f32_bf16 v242, s66, v161
    v_dot2c_f32_bf16 v242, s66, v162
    v_dot2c_f32_bf16 v242, s66, v163
    s_lshl_b32 s67, s52, 8
    s_add_u32 s67, s67, 159744
    v_lshrrev_b32 v243, 2, v1
    v_add_u32 v243, s67, v243
    ds_write_b32 v243, v242
    s_waitcnt lgkmcnt(0)
    s_or_b32 s59, s59, 0x40004000
    s_add_u32 s59, s59, 1
    s_and_b32 s59, s59, 0xbfffbfff
    v_mov_b32 v14, s59
    s_mov_b32 s63, 0
    v_bfe_u32 v240, v1, 4, 5
    v_bfe_u32 v241, v1, 5, 3
    v_lshrrev_b32 v242, 9, v1
    v_xor_b32 v241, v241, v242
    v_lshlrev_b32 v241, 4, v241
    v_lshl_add_u32 v2, v240, 7, v241
    s_lshl1_add_u32 s66, s64, 16384
    v_add_u32 v2, s66, v2
    v_xor_b32 v3, 32, v2
    v_xor_b32 v4, 64, v2
    v_xor_b32 v5, 96, v2
    v_add_u32 v6, 131072, v1
    v_lshrrev_b32 v15, 2, v1
    v_add_u32 v15, 159744, v15
    v_lshrrev_b32 v48, 7, v1
    v_mul_u32_u24 v7, 3584, v48
    v_and_b32 v48, 2, v48
    v_bfe_u32 v49, v1, 5, 2
    v_xor_b32 v48, v48, v49
    v_lshl_add_u32 v7, v48, 5, v7
    v_and_b32 v48, 16, v1
    s_mul_i32 s66, s53, 57344
    s_lshl_b32 s67, s55, 7
    s_add_u32 s66, s66, s67
    v_add3_u32 v7, v7, v48, s66
    v_xor_b32 v8, 32, v7
    s_mov_b64 s[28:29], s[12:13]
    s_mov_b32 s30, 0x188000
    s_mov_b32 s31, 0x20000
    s_mov_b64 s[32:33], s[14:15]
    s_mov_b32 s34, 0x188000
    s_mov_b32 s35, 0x20000
    s_add_u32 s67, s54, 0
    s_and_b32 s67, s67, 3
    s_and_b32 s68, s54, 3
    s_mul_i32 s67, s67, 6
    s_mul_i32 s68, s68, 6
    s_bfe_u32 s66, s58, 0x40000
    s_add_u32 s67, s67, s66
    s_add_u32 s67, s67, s68
    s_mul_i32 s68, s67, 37
    s_lshr_b32 s68, s68, 8
    s_mul_i32 s68, s68, 7
    s_sub_u32 s67, s67, s68
    s_lshl_b32 s67, s67, 2
    s_mov_b32 s68, 0x06543210
    s_mov_b32 s69, 0x00654321
    s_lshr_b64 s[68:69], s[68:69], s67
    s_mov_b32 s10, s68
    s_lshl1_add_u32 s11, s54, s56
    s_mul_i32 s62, s11, 229376
    s_add_u32 s62, s62, 5242880
    s_lshl_b32 s8, s11, 12
    s_add_u32 s8, s8, 4456448
    s_lshl_b32 s11, s11, 11
    s_add_u32 s11, s11, 12582912
    s_mul_i32 s51, s61, 28
    s_add_u32 s51, s51, s55
    s_lshl_b32 s51, s51, 12
    s_add_u32 s51, s51, 5242880
    s_mul_i32 s65, s53, 7
    s_bfe_u32 s66, s10, 0x40000
    s_lshl1_add_u32 s66, s66, s53
    s_lshr_b32 s69, s53, 1
    s_lshl_b32 s6, s69, 24
    s_mov_b32 s7, 0x010101
    s_mul_i32 s69, s69, 14
    s_add_u32 s67, s66, 0
    s_sub_u32 s68, s67, 14
    s_cselect_b32 s67, s67, s68
    s_lshl_b32 s67, s67, 1
    s_or_b32 s6, s6, s67
    s_add_u32 s67, s66, 4
    s_sub_u32 s68, s67, 14
    s_cselect_b32 s67, s67, s68
    s_lshl_b32 s67, s67, 9
    s_or_b32 s6, s6, s67
    s_add_u32 s67, s66, 8
    s_sub_u32 s68, s67, 14
    s_cselect_b32 s67, s67, s68
    s_lshl_b32 s67, s67, 17
    s_or_b32 s6, s6, s67
    s_add_u32 s67, s66, 12
    s_sub_u32 s67, s67, s69
    s_sub_u32 s68, s67, 14
    s_cselect_b32 s67, s67, s68
    s_lshl_b32 s67, s67, 25
    s_or_b32 s6, s6, s67
    s_add_u32 s67, s66, 2
    s_sub_u32 s68, s67, 14
    s_cselect_b32 s67, s67, s68
    s_lshl_b32 s67, s67, 1
    s_or_b32 s7, s7, s67
    s_add_u32 s67, s66, 6
    s_sub_u32 s68, s67, 14
    s_cselect_b32 s67, s67, s68
    s_lshl_b32 s67, s67, 9
    s_or_b32 s7, s7, s67
    s_add_u32 s67, s66, 10
    s_sub_u32 s68, s67, 14
    s_cselect_b32 s67, s67, s68
    s_lshl_b32 s67, s67, 17
    s_or_b32 s7, s7, s67
    v_bfe_u32 v48, v1, 8, 1
    v_bfe_u32 v49, v1, 6, 2
    v_lshrrev_b32 v50, 9, v1
    v_lshl_add_u32 v10, v50, 2, v49
    v_lshlrev_b32 v10, 7, v10
    v_bfe_u32 v51, v1, 7, 1
    v_lshl_add_u32 v10, v51, 6, v10
    v_lshl_add_u32 v10, v48, 5, v10
    v_bfe_u32 v51, v1, 4, 2
    v_lshl_add_u32 v10, v51, 3, v10
    s_lshl1_add_u32 s66, s64, 98304
    v_add_u32 v10, s66, v10
    v_xor_b32 v11, 64, v10
    v_lshrrev_b32 v49, 7, v1
    v_mul_u32_u24 v9, 896, v49
    v_lshlrev_b32 v48, 6, v48
    v_and_b32 v51, 0x70, v1
    v_xor_b32 v48, v48, v51
    s_lshl_b32 s67, s57, 7
    v_add3_u32 v9, v9, v48, s67
    s_mov_b64 s[36:37], s[16:17]
    s_mov_b32 s38, 0x188000
    s_mov_b32 s39, 0x20000
    s_lshl_b32 s73, s55, 6
    s_add_u32 s73, s73, s61
    s_lshl_b32 s73, s73, 7
    s_add_u32 s73, s73, 4194304
    v_bfe_u32 v240, v1, 4, 5
    v_cvt_f32_u32 v240, v240
    v_lshrrev_b32 v241, 9, v1
    v_lshlrev_b32 v241, 8, v241
    v_add_u32 v241, s60, v241
    v_cvt_f32_u32 v241, v241
    v_mul_f32 v241, 0x3a000000, v241
    v_mul_f32 v241, v241, v240
    v_mul_f32 v240, 0x3d000000, v240
    v_fmamk_f32 v244, v240, 0x00000000, v241
    v_sin_f32 v246, v244
    v_cos_f32 v244, v244
    v_fmamk_f32 v245, v240, 0x3f800000, v241
    v_sin_f32 v247, v245
    v_cos_f32 v245, v245
    v_cvt_pk_bf16_f32 v104, v246, v247
    v_cvt_pk_bf16_f32 v96, v244, v245
    v_fmamk_f32 v248, v240, 0x40000000, v241
    v_sin_f32 v250, v248
    v_cos_f32 v248, v248
    v_fmamk_f32 v249, v240, 0x40400000, v241
    v_sin_f32 v251, v249
    v_cos_f32 v249, v249
    v_cvt_pk_bf16_f32 v105, v250, v251
    v_cvt_pk_bf16_f32 v97, v248, v249
    v_fmamk_f32 v244, v240, 0x41000000, v241
    v_sin_f32 v246, v244
    v_cos_f32 v244, v244
    v_fmamk_f32 v245, v240, 0x41100000, v241
    v_sin_f32 v247, v245
    v_cos_f32 v245, v245
    v_cvt_pk_bf16_f32 v106, v246, v247
    v_cvt_pk_bf16_f32 v98, v244, v245
    v_fmamk_f32 v248, v240, 0x41200000, v241
    v_sin_f32 v250, v248
    v_cos_f32 v248, v248
    v_fmamk_f32 v249, v240, 0x41300000, v241
    v_sin_f32 v251, v249
    v_cos_f32 v249, v249
    v_cvt_pk_bf16_f32 v107, v250, v251
    v_cvt_pk_bf16_f32 v99, v248, v249
    v_fmamk_f32 v244, v240, 0x41800000, v241
    v_sin_f32 v246, v244
    v_cos_f32 v244, v244
    v_fmamk_f32 v245, v240, 0x41880000, v241
    v_sin_f32 v247, v245
    v_cos_f32 v245, v245
    v_cvt_pk_bf16_f32 v108, v246, v247
    v_cvt_pk_bf16_f32 v100, v244, v245
    v_fmamk_f32 v248, v240, 0x41900000, v241
    v_sin_f32 v250, v248
    v_cos_f32 v248, v248
    v_fmamk_f32 v249, v240, 0x41980000, v241
    v_sin_f32 v251, v249
    v_cos_f32 v249, v249
    v_cvt_pk_bf16_f32 v109, v250, v251
    v_cvt_pk_bf16_f32 v101, v248, v249
    v_fmamk_f32 v244, v240, 0x41c00000, v241
    v_sin_f32 v246, v244
    v_cos_f32 v244, v244
    v_fmamk_f32 v245, v240, 0x41c80000, v241
    v_sin_f32 v247, v245
    v_cos_f32 v245, v245
    v_cvt_pk_bf16_f32 v110, v246, v247
    v_cvt_pk_bf16_f32 v102, v244, v245
    v_fmamk_f32 v248, v240, 0x41d00000, v241
    v_sin_f32 v250, v248
    v_cos_f32 v248, v248
    v_fmamk_f32 v249, v240, 0x41d80000, v241
    v_sin_f32 v251, v249
    v_cos_f32 v249, v249
    v_cvt_pk_bf16_f32 v111, v250, v251
    v_cvt_pk_bf16_f32 v103, v248, v249
    v_mov_b32 v76, -1
    v_mov_b32 v77, -1
    v_mov_b32 v78, -1
    v_mov_b32 v79, -1
    s_lshl_b32 s71, s55, 7
    s_add_u32 s71, s71, s61
    s_lshl_b32 s71, s71, 10
    s_add_u32 s70, s71, 0
    buffer_store_dwordx4 v[76:79], v1, s[40:43], s70 offen sc1
    s_add_u32 s70, s71, 65536
    buffer_store_dwordx4 v[76:79], v1, s[40:43], s70 offen sc1
    s_add_u32 s70, s71, 12582912
    buffer_store_dwordx4 v[76:79], v1, s[40:43], s70 offen sc1
    s_add_u32 s70, s71, 12648448
    buffer_store_dwordx4 v[76:79], v1, s[40:43], s70 offen sc1
    s_cmp_lg_u32 s55, 0
    s_cbranch_scc1 nonyq_17
    s_add_u32 s70, s71, 1835008
    buffer_store_dwordx4 v[76:79], v1, s[40:43], s70 offen sc1
    s_add_u32 s70, s71, 14417920
    buffer_store_dwordx4 v[76:79], v1, s[40:43], s70 offen sc1
nonyq_17:
    s_barrier
    ds_read_b128 v[144:147], v2 offset:0
    ds_read_b128 v[148:151], v3 offset:0
    ds_read_b128 v[152:155], v4 offset:0
    ds_read_b128 v[156:159], v5 offset:0
    ds_read_b128 v[176:179], v6 offset:0
    ds_read_b128 v[180:183], v6 offset:1024
    ds_read_b128 v[184:187], v6 offset:2048
    ds_read_b128 v[188:191], v6 offset:3072
    ds_read_b128 v[160:163], v2 offset:16384
    ds_read_b128 v[164:167], v3 offset:16384
    ds_read_b128 v[168:171], v4 offset:16384
    ds_read_b128 v[172:175], v5 offset:16384
    ds_read_b128 v[192:195], v6 offset:4096
    ds_read_b128 v[196:199], v6 offset:5120
    ds_read_b128 v[200:203], v6 offset:6144
    ds_read_b128 v[204:207], v6 offset:7168
    ds_read_b32 v32, v15 offset:0
    ds_read_b32 v33, v15 offset:256
    ds_read_b32 v34, v15 offset:512
    ds_read_b32 v35, v15 offset:768
    ds_read_b32 v36, v15 offset:1024
    ds_read_b32 v37, v15 offset:1280
    ds_read_b32 v38, v15 offset:1536
    ds_read_b32 v39, v15 offset:1792
    ds_read_b128 v[208:211], v6 offset:8192
    ds_read_b128 v[212:215], v6 offset:9216
    ds_read_b128 v[216:219], v6 offset:10240
    ds_read_b128 v[220:223], v6 offset:11264
    ds_read_b128 v[224:227], v6 offset:12288
    ds_read_b128 v[228:231], v6 offset:13312
    ds_read_b128 v[232:235], v6 offset:14336
    ds_read_b128 v[236:239], v6 offset:15360
    s_waitcnt lgkmcnt(15)
    v_mfma_f32_32x32x16_bf16 v[16:31], v[144:147], v[176:179], 0
    s_waitcnt lgkmcnt(11)
    v_add_f32 v32, v32, v36
    s_waitcnt lgkmcnt(10)
    v_add_f32 v33, v33, v37
    s_waitcnt lgkmcnt(9)
    v_add_f32 v34, v34, v38
    s_waitcnt lgkmcnt(8)
    v_add_f32 v35, v35, v39
    v_add_f32 v32, v32, v34
    v_add_f32 v33, v33, v35
    v_mfma_f32_32x32x16_bf16 v[16:31], v[148:151], v[180:183], v[16:31]
    v_add_f32 v32, v32, v33
    v_cvt_pk_bf16_f32 v33, v32, v32
    v_and_b32 v33, 0xffff0000, v33
    v_sub_f32 v33, v32, v33
    v_cvt_pk_bf16_f32 v72, v32, v33
    v_mov_b32 v73, 0
    v_mov_b32 v69, 0
    v_mfma_f32_32x32x16_bf16 v[16:31], v[152:155], v[184:187], v[16:31]
    v_mov_b32 v74, 0
    v_mov_b32 v70, 0
    v_mov_b32 v75, 0
    v_mov_b32 v71, 0
    s_cmp_eq_u32 s55, 0
    s_cselect_b32 s20, 3, 0
    s_mov_b32 s21, s20
    s_and_b32 s80, s20, 2
    s_mov_b32 s81, s80
    v_mfma_f32_32x32x16_bf16 v[16:31], v[156:159], v[188:191], v[16:31]
    v_and_b32 v12, 0xf0, v1
    v_bfe_u32 v13, v1, 8, 1
    v_lshl_add_u32 v12, v13, 16, v12
    v_mov_b32 v13, 1835008
    v_cndmask_b32 v12, v12, v13, s[80:81]
    v_lshrrev_b32 v13, 9, v1
    ds_read_b128 v[176:179], v6 offset:16384
    ds_read_b128 v[180:183], v6 offset:17408
    ds_read_b128 v[184:187], v6 offset:18432
    ds_read_b128 v[188:191], v6 offset:19456
    s_waitcnt lgkmcnt(0)
    s_barrier
    ds_read_b128 v[80:83], v2 offset:32768
    ds_read_b128 v[84:87], v3 offset:32768
    ds_read_b128 v[88:91], v4 offset:32768
    ds_read_b128 v[92:95], v5 offset:32768
    ds_read_b128 v[112:115], v2 offset:49152
    ds_read_b128 v[116:119], v3 offset:49152
    ds_read_b128 v[120:123], v4 offset:49152
    ds_read_b128 v[124:127], v5 offset:49152
    v_mfma_f32_32x32x16_bf16 v[16:31], v[160:163], v[192:195], v[16:31]
    v_lshl_add_u32 v12, v13, 8, v12
    v_cndmask_b32 v0, 1.0, 0, s[20:21]
    v_bfe_i32 v136, v1, 4, 1
    v_lshlrev_b32 v137, 4, v13
    v_and_b32 v13, 0x80008000, v136
    v_bfe_u32 v136, v1, 4, 5
    v_mfma_f32_32x32x16_bf16 v[16:31], v[164:167], v[196:199], v[16:31]
    s_lshl_b32 s66, s53, 7
    s_add_u32 s66, s66, 161792
    v_lshl_add_u32 v136, v136, 2, s66
    v_add_u32 v137, s66, v137
    v_mfma_f32_32x32x16_bf16 v[16:31], v[168:171], v[200:203], v[16:31]
    v_mfma_f32_32x32x16_bf16 v[16:31], v[172:175], v[204:207], v[16:31]
    ds_read_b128 v[192:195], v6 offset:20480
    ds_read_b128 v[196:199], v6 offset:21504
    ds_read_b128 v[200:203], v6 offset:22528
    ds_read_b128 v[204:207], v6 offset:23552
    s_waitcnt lgkmcnt(11)
    v_mfma_f32_32x32x16_bf16 v[16:31], v[80:83], v[208:211], v[16:31]
    s_waitcnt lgkmcnt(10)
    v_mfma_f32_32x32x16_bf16 v[16:31], v[84:87], v[212:215], v[16:31]
    s_waitcnt lgkmcnt(9)
    v_mfma_f32_32x32x16_bf16 v[16:31], v[88:91], v[216:219], v[16:31]
    s_waitcnt lgkmcnt(8)
    v_mfma_f32_32x32x16_bf16 v[16:31], v[92:95], v[220:223], v[16:31]
    ds_read_b128 v[208:211], v6 offset:24576
    ds_read_b128 v[212:215], v6 offset:25600
    ds_read_b128 v[216:219], v6 offset:26624
    ds_read_b128 v[220:223], v6 offset:27648
    s_waitcnt lgkmcnt(0)
    s_barrier
    v_add_u32 v2, 65536, v2
    v_add_u32 v3, 65536, v3
    v_add_u32 v4, 65536, v4
    v_add_u32 v5, 65536, v5
    ds_read_b128 v[144:147], v2 offset:0
    ds_read_b128 v[148:151], v3 offset:0
    ds_read_b128 v[152:155], v4 offset:0
    ds_read_b128 v[156:159], v5 offset:0
    ds_read_b128 v[160:163], v2 offset:16384
    ds_read_b128 v[164:167], v3 offset:16384
    ds_read_b128 v[168:171], v4 offset:16384
    ds_read_b128 v[172:175], v5 offset:16384
    v_mfma_f32_32x32x16_bf16 v[16:31], v[112:115], v[224:227], v[16:31]
    v_mfma_f32_32x32x16_bf16 v[16:31], v[116:119], v[228:231], v[16:31]
    v_mfma_f32_32x32x16_bf16 v[16:31], v[120:123], v[232:235], v[16:31]
    v_mfma_f32_32x32x16_bf16 v[16:31], v[124:127], v[236:239], v[16:31]
    s_waitcnt lgkmcnt(7)
    v_mfma_f32_32x32x16_bf16 v[16:31], v[144:147], v[176:179], v[16:31]
    s_waitcnt lgkmcnt(6)
    v_mfma_f32_32x32x16_bf16 v[16:31], v[148:151], v[180:183], v[16:31]
    s_waitcnt lgkmcnt(5)
    v_mfma_f32_32x32x16_bf16 v[16:31], v[152:155], v[184:187], v[16:31]
    s_waitcnt lgkmcnt(4)
    v_mfma_f32_32x32x16_bf16 v[16:31], v[156:159], v[188:191], v[16:31]
    s_bfe_u32 s70, s58, 0x40008
    s_mul_i32 s70, s70, 229376
    s_add_u32 s71, s70, 27648
    s_add_u32 m0, s64, 32768
    s_nop 0
    buffer_load_dwordx4 v7, s[28:31], s70 offen offset:0 lds
    buffer_load_dwordx4 v7, s[28:31], s71 offen offset:1024 lds
    s_add_u32 m0, s64, 40960
    s_nop 0
    buffer_load_dwordx4 v8, s[32:35], s70 offen offset:0 lds
    buffer_load_dwordx4 v8, s[32:35], s71 offen offset:1024 lds
    s_waitcnt lgkmcnt(0)
    s_barrier
    ds_read_b128 v[80:83], v2 offset:32768
    ds_read_b128 v[84:87], v3 offset:32768
    ds_read_b128 v[88:91], v4 offset:32768
    ds_read_b128 v[92:95], v5 offset:32768
    v_mfma_f32_32x32x16_bf16 v[16:31], v[160:163], v[192:195], v[16:31]
    v_mfma_f32_32x32x16_bf16 v[16:31], v[164:167], v[196:199], v[16:31]
    v_mfma_f32_32x32x16_bf16 v[16:31], v[168:171], v[200:203], v[16:31]
    v_mfma_f32_32x32x16_bf16 v[16:31], v[172:175], v[204:207], v[16:31]
    s_waitcnt lgkmcnt(3)
    v_mfma_f32_32x32x16_bf16 v[16:31], v[80:83], v[208:211], v[16:31]
    s_waitcnt lgkmcnt(2)
    v_mfma_f32_32x32x16_bf16 v[16:31], v[84:87], v[212:215], v[16:31]
    s_waitcnt lgkmcnt(1)
    v_mfma_f32_32x32x16_bf16 v[16:31], v[88:91], v[216:219], v[16:31]
    s_waitcnt lgkmcnt(0)
    v_mfma_f32_32x32x16_bf16 v[16:31], v[92:95], v[220:223], v[16:31]
    s_bfe_u32 s70, s58, 0x4000c
    s_mul_i32 s70, s70, 229376
    s_add_u32 s71, s70, 27648
    s_add_u32 m0, s64, 49152
    s_nop 0
    buffer_load_dwordx4 v7, s[28:31], s70 offen offset:0 lds
    buffer_load_dwordx4 v7, s[28:31], s71 offen offset:1024 lds
    s_add_u32 m0, s64, 57344
    s_nop 0
    buffer_load_dwordx4 v8, s[32:35], s70 offen offset:0 lds
    buffer_load_dwordx4 v8, s[32:35], s71 offen offset:1024 lds
    s_bfe_u32 s70, s58, 0x40010
    s_mul_i32 s70, s70, 229376
    s_add_u32 s71, s70, 27648
    s_add_u32 m0, s64, 65536
    s_nop 0
    buffer_load_dwordx4 v7, s[28:31], s70 offen offset:0 lds
    buffer_load_dwordx4 v7, s[28:31], s71 offen offset:1024 lds
    s_barrier
    ds_read_b32 v68, v136
    ds_read_b128 v[112:115], v137 offset:512
    ds_read_b128 v[116:119], v137 offset:544
    ds_read_b128 v[120:123], v137 offset:576
    ds_read_b128 v[124:127], v137 offset:608
    s_waitcnt lgkmcnt(4)
    v_mfma_f32_32x32x16_bf16 v[16:31], v[68:71], v[72:75], v[16:31]
    s_add_u32 m0, s64, 73728
    s_nop 0
    buffer_load_dwordx4 v8, s[32:35], s70 offen offset:0 lds
    buffer_load_dwordx4 v8, s[32:35], s71 offen offset:1024 lds
    s_waitcnt lgkmcnt(3)
    s_nop 6
    v_mul_f32 v16, v16, v112
    v_mul_f32 v17, v17, v113
    v_mul_f32 v18, v18, v114
    v_mul_f32 v19, v19, v115
    s_waitcnt lgkmcnt(2)
    v_mul_f32 v20, v20, v116
    v_mul_f32 v21, v21, v117
    v_mul_f32 v22, v22, v118
    v_mul_f32 v23, v23, v119
    v_cvt_pk_bf16_f32 v128, v16, v17
    v_cvt_pk_bf16_f32 v129, v18, v19
    v_cvt_pk_bf16_f32 v130, v20, v21
    v_cvt_pk_bf16_f32 v131, v22, v23
    v_xor_b32_dpp v136, v128, v13 quad_perm:[1,0,3,2] row_mask:0xf bank_mask:0xf
    v_xor_b32_dpp v137, v129, v13 quad_perm:[1,0,3,2] row_mask:0xf bank_mask:0xf
    v_xor_b32_dpp v138, v130, v13 quad_perm:[1,0,3,2] row_mask:0xf bank_mask:0xf
    v_xor_b32_dpp v139, v131, v13 quad_perm:[1,0,3,2] row_mask:0xf bank_mask:0xf
    v_mfma_f32_32x32x16_bf16 v[32:47], v[96:99], v[128:131], 0
    s_mov_b64 exec, s[20:21]
    v_xor_b32 v136, 0x80008000, v128
    v_xor_b32 v137, 0x80008000, v129
    v_xor_b32 v138, 0x80008000, v130
    v_xor_b32 v139, 0x80008000, v131
    s_mov_b64 exec, -1
    s_nop 0
    v_mfma_f32_32x32x16_bf16 v[48:63], v[104:107], v[136:139], 0
    s_waitcnt lgkmcnt(1)
    v_mul_f32 v24, v24, v120
    v_mul_f32 v25, v25, v121
    v_mul_f32 v26, v26, v122
    v_mul_f32 v27, v27, v123
    s_waitcnt lgkmcnt(0)
    v_mul_f32 v28, v28, v124
    v_mul_f32 v29, v29, v125
    v_mul_f32 v30, v30, v126
    v_mul_f32 v31, v31, v127
    v_cvt_pk_bf16_f32 v132, v24, v25
    v_cvt_pk_bf16_f32 v133, v26, v27
    v_cvt_pk_bf16_f32 v134, v28, v29
    v_cvt_pk_bf16_f32 v135, v30, v31
    v_xor_b32_dpp v140, v132, v13 quad_perm:[1,0,3,2] row_mask:0xf bank_mask:0xf
    v_xor_b32_dpp v141, v133, v13 quad_perm:[1,0,3,2] row_mask:0xf bank_mask:0xf
    v_xor_b32_dpp v142, v134, v13 quad_perm:[1,0,3,2] row_mask:0xf bank_mask:0xf
    v_xor_b32_dpp v143, v135, v13 quad_perm:[1,0,3,2] row_mask:0xf bank_mask:0xf
    v_mfma_f32_32x32x16_bf16 v[32:47], v[100:103], v[132:135], v[32:47]
    s_mov_b64 exec, s[20:21]
    v_xor_b32 v140, 0x80008000, v132
    v_xor_b32 v141, 0x80008000, v133
    v_xor_b32 v142, 0x80008000, v134
    v_xor_b32 v143, 0x80008000, v135
    s_mov_b64 exec, -1
    s_nop 0
    v_mfma_f32_32x32x16_bf16 v[48:63], v[108:111], v[140:143], v[48:63]
    s_bfe_u32 s70, s58, 0x40014
    s_mul_i32 s70, s70, 229376
    s_add_u32 s71, s70, 27648
    s_add_u32 m0, s64, 81920
    s_nop 0
    buffer_load_dwordx4 v7, s[28:31], s70 offen offset:0 lds
    buffer_load_dwordx4 v7, s[28:31], s71 offen offset:1024 lds
    s_add_u32 m0, s64, 90112
    s_nop 0
    buffer_load_dwordx4 v8, s[32:35], s70 offen offset:0 lds
    buffer_load_dwordx4 v8, s[32:35], s71 offen offset:1024 lds
    s_waitcnt vmcnt(16)
    s_mov_b64 exec, 255
    buffer_store_dwordx4 v[12:15], v1, s[40:43], s73 offen sc1
    s_mov_b64 exec, -1
    v_fmac_f32 v32, v48, v0
    v_fmac_f32 v33, v49, v0
    v_fmac_f32 v34, v50, v0
    v_fmac_f32 v35, v51, v0
    v_fmac_f32 v36, v52, v0
    v_fmac_f32 v37, v53, v0
    v_fmac_f32 v38, v54, v0
    v_fmac_f32 v39, v55, v0
    v_cvt_pk_bf16_f32 v128, v32, v33
    v_cvt_pk_bf16_f32 v129, v34, v35
    v_cvt_pk_bf16_f32 v130, v36, v37
    v_cvt_pk_bf16_f32 v131, v38, v39
    buffer_store_dwordx4 v[128:131], v12, s[40:43], s3 offen offset:0 sc1
    v_fmac_f32 v40, v56, v0
    v_fmac_f32 v41, v57, v0
    v_fmac_f32 v42, v58, v0
    v_fmac_f32 v43, v59, v0
    v_fmac_f32 v44, v60, v0
    v_fmac_f32 v45, v61, v0
    v_fmac_f32 v46, v62, v0
    v_fmac_f32 v47, v63, v0
    v_cvt_pk_bf16_f32 v132, v40, v41
    v_cvt_pk_bf16_f32 v133, v42, v43
    v_cvt_pk_bf16_f32 v134, v44, v45
    v_cvt_pk_bf16_f32 v135, v46, v47
    buffer_store_dwordx4 v[132:135], v12, s[40:43], s3 offen offset:512 sc1
    s_cmp_lg_u32 s55, 0
    s_cbranch_scc1 nonyq_18
    v_cvt_pk_bf16_f32 v136, v48, v49
    v_cvt_pk_bf16_f32 v137, v50, v51
    v_cvt_pk_bf16_f32 v138, v52, v53
    v_cvt_pk_bf16_f32 v139, v54, v55
    v_cvt_pk_bf16_f32 v140, v56, v57
    v_cvt_pk_bf16_f32 v141, v58, v59
    v_cvt_pk_bf16_f32 v142, v60, v61
    v_cvt_pk_bf16_f32 v143, v62, v63
    s_mov_b64 exec, s[20:21]
    buffer_store_dwordx4 v[136:139], v12, s[40:43], s3 offen offset:16 sc1
    buffer_store_dwordx4 v[140:143], v12, s[40:43], s3 offen offset:528 sc1
    s_mov_b64 exec, -1
nonyq_18:
    v_bfe_u32 v6, v1, 4, 2
    s_lshr_b32 s66, s65, 1
    v_add_lshl_u32 v6, v6, s66, 7
    v_bfe_u32 v12, v1, 6, 1
    v_lshl_add_u32 v6, v12, 11, v6
    v_lshrrev_b32 v2, 5, v1
    v_and_b32 v2, 16, v2
    v_xor_b32 v2, v2, v1
    s_lshl1_add_u32 s66, s64, 0
    v_add_u32 v2, s66, v2
    v_xor_b32 v3, 32, v2
    v_xor_b32 v4, 64, v2
    v_xor_b32 v5, 96, v2
    s_bfe_u32 s70, s10, 0x40000
    s_add_u32 s70, s70, s65
    s_mul_i32 s70, s70, 28672
    s_lshl1_add_u32 m0, s64, 114688
    s_nop 0
    buffer_load_dwordx4 v9, s[36:39], s70 offen offset:0 lds
    s_add_u32 s70, s70, 6144
    buffer_load_dwordx4 v9, s[36:39], s70 offen offset:1024 lds
    s_add_u32 s70, s70, 6144
    buffer_load_dwordx4 v9, s[36:39], s70 offen offset:2048 lds
    s_add_u32 s70, s70, 6144
    buffer_load_dwordx4 v9, s[36:39], s70 offen offset:3072 lds
    s_waitcnt vmcnt(15)
    s_barrier
    s_bfe_u32 s70, s58, 0x40018
    s_mul_i32 s70, s70, 229376
    s_add_u32 s71, s70, 27648
    s_add_u32 m0, s64, 0
    s_nop 0
    buffer_load_dwordx4 v7, s[28:31], s70 offen offset:0 lds
    buffer_load_dwordx4 v7, s[28:31], s71 offen offset:1024 lds
    s_add_u32 m0, s64, 8192
    s_nop 0
    buffer_load_dwordx4 v8, s[32:35], s70 offen offset:0 lds
    buffer_load_dwordx4 v8, s[32:35], s71 offen offset:1024 lds
    s_bfe_u32 s70, s58, 0x40000
    s_mul_i32 s70, s70, 229376
    s_add_u32 s71, s70, 29440
    s_add_u32 s70, s70, 1792
    s_add_u32 m0, s64, 16384
    s_nop 0
    buffer_load_dwordx4 v7, s[28:31], s70 offen offset:0 lds
    buffer_load_dwordx4 v7, s[28:31], s71 offen offset:1024 lds
    s_add_u32 m0, s64, 24576
    s_nop 0
    buffer_load_dwordx4 v8, s[32:35], s70 offen offset:0 lds
    buffer_load_dwordx4 v8, s[32:35], s71 offen offset:1024 lds
    s_bfe_u32 s70, s10, 0x40004
    s_add_u32 s70, s70, s65
    s_mul_i32 s70, s70, 28672
    s_lshl1_add_u32 m0, s64, 131072
    s_nop 0
    buffer_load_dwordx4 v9, s[36:39], s70 offen offset:0 lds
    s_add_u32 s70, s70, 6144
    buffer_load_dwordx4 v9, s[36:39], s70 offen offset:1024 lds
    s_add_u32 s70, s70, 6144
    buffer_load_dwordx4 v9, s[36:39], s70 offen offset:2048 lds
    s_add_u32 s70, s70, 6144
    buffer_load_dwordx4 v9, s[36:39], s70 offen offset:3072 lds
    s_waitcnt vmcnt(19)
    s_barrier
    s_bfe_u32 s70, s58, 0x40004
    s_mul_i32 s70, s70, 229376
    s_add_u32 s71, s70, 29440
    s_add_u32 s70, s70, 1792
    s_add_u32 m0, s64, 32768
    s_nop 0
    buffer_load_dwordx4 v7, s[28:31], s70 offen offset:0 lds
    buffer_load_dwordx4 v7, s[28:31], s71 offen offset:1024 lds
    s_add_u32 m0, s64, 40960
    s_nop 0
    buffer_load_dwordx4 v8, s[32:35], s70 offen offset:0 lds
    buffer_load_dwordx4 v8, s[32:35], s71 offen offset:1024 lds
    s_bfe_u32 s70, s58, 0x40008
    s_mul_i32 s70, s70, 229376
    s_add_u32 s71, s70, 29440
    s_add_u32 s70, s70, 1792
    s_add_u32 m0, s64, 49152
    s_nop 0
    buffer_load_dwordx4 v7, s[28:31], s70 offen offset:0 lds
    buffer_load_dwordx4 v7, s[28:31], s71 offen offset:1024 lds
    s_add_u32 m0, s64, 57344
    s_nop 0
    buffer_load_dwordx4 v8, s[32:35], s70 offen offset:0 lds
    buffer_load_dwordx4 v8, s[32:35], s71 offen offset:1024 lds
    s_bfe_u32 s70, s10, 0x40008
    s_add_u32 s70, s70, s65
    s_mul_i32 s70, s70, 28672
    s_lshl1_add_u32 m0, s64, 98304
    s_nop 0
    buffer_load_dwordx4 v9, s[36:39], s70 offen offset:0 lds
    s_add_u32 s70, s70, 6144
    buffer_load_dwordx4 v9, s[36:39], s70 offen offset:1024 lds
    s_add_u32 s70, s70, 6144
    buffer_load_dwordx4 v9, s[36:39], s70 offen offset:2048 lds
    s_add_u32 s70, s70, 6144
    buffer_load_dwordx4 v9, s[36:39], s70 offen offset:3072 lds
    s_bfe_u32 s70, s10, 0x4000c
    s_add_u32 s70, s70, s65
    s_mul_i32 s70, s70, 28672
    s_lshl1_add_u32 m0, s64, 147456
    s_nop 0
    buffer_load_dwordx4 v9, s[36:39], s70 offen offset:0 lds
    s_add_u32 s70, s70, 6144
    buffer_load_dwordx4 v9, s[36:39], s70 offen offset:1024 lds
    s_add_u32 s70, s70, 6144
    buffer_load_dwordx4 v9, s[36:39], s70 offen offset:2048 lds
    s_add_u32 s70, s70, 6144
    buffer_load_dwordx4 v9, s[36:39], s70 offen offset:3072 lds
    s_waitcnt vmcnt(28)
    ds_read_b64_tr_b16 v[80:81], v10 offset:16384
    ds_read_b64_tr_b16 v[82:83], v10 offset:17408
    ds_read_b64_tr_b16 v[84:85], v11 offset:16384
    ds_read_b64_tr_b16 v[86:87], v11 offset:17408
    ds_read_b64_tr_b16 v[88:89], v10 offset:18432
    ds_read_b64_tr_b16 v[90:91], v10 offset:19456
    ds_read_b64_tr_b16 v[92:93], v11 offset:18432
    ds_read_b64_tr_b16 v[94:95], v11 offset:19456
    s_waitcnt vmcnt(16)
    ds_read_b64_tr_b16 v[96:97], v10 offset:32768
    ds_read_b64_tr_b16 v[98:99], v10 offset:33792
    ds_read_b64_tr_b16 v[100:101], v11 offset:32768
    ds_read_b64_tr_b16 v[102:103], v11 offset:33792
    ds_read_b64_tr_b16 v[104:105], v10 offset:34816
    ds_read_b64_tr_b16 v[106:107], v10 offset:35840
    ds_read_b64_tr_b16 v[108:109], v11 offset:34816
    ds_read_b64_tr_b16 v[110:111], v11 offset:35840
    s_add_u32 s71, s51, 57344
    buffer_store_dwordx4 v[76:79], v1, s[40:43], s71 offen offset:0 sc1
    buffer_store_dwordx4 v[76:79], v1, s[40:43], s71 offen offset:1024 sc1
    buffer_store_dwordx4 v[76:79], v1, s[40:43], s71 offen offset:2048 sc1
    buffer_store_dwordx4 v[76:79], v1, s[40:43], s71 offen offset:3072 sc1
    s_waitcnt lgkmcnt(0)
    s_barrier
    s_bfe_u32 s70, s58, 0x4000c
    s_mul_i32 s70, s70, 229376
    s_add_u32 s71, s70, 29440
    s_add_u32 s70, s70, 1792
    s_add_u32 m0, s64, 65536
    s_nop 0
    buffer_load_dwordx4 v7, s[28:31], s70 offen offset:0 lds
    buffer_load_dwordx4 v7, s[28:31], s71 offen offset:1024 lds
    s_add_u32 m0, s64, 73728
    s_nop 0
    buffer_load_dwordx4 v8, s[32:35], s70 offen offset:0 lds
    buffer_load_dwordx4 v8, s[32:35], s71 offen offset:1024 lds
    s_bfe_u32 s70, s58, 0x40010
    s_mul_i32 s70, s70, 229376
    s_add_u32 s71, s70, 29440
    s_add_u32 s70, s70, 1792
    s_add_u32 m0, s64, 81920
    s_nop 0
    buffer_load_dwordx4 v7, s[28:31], s70 offen offset:0 lds
    buffer_load_dwordx4 v7, s[28:31], s71 offen offset:1024 lds
    s_add_u32 m0, s64, 90112
    s_nop 0
    buffer_load_dwordx4 v8, s[32:35], s70 offen offset:0 lds
    buffer_load_dwordx4 v8, s[32:35], s71 offen offset:1024 lds
    s_bfe_u32 s70, s10, 0x40010
    s_add_u32 s70, s70, s65
    s_mul_i32 s70, s70, 28672
    s_lshl1_add_u32 m0, s64, 114688
    s_nop 0
    buffer_load_dwordx4 v9, s[36:39], s70 offen offset:0 lds
    s_add_u32 s70, s70, 6144
    buffer_load_dwordx4 v9, s[36:39], s70 offen offset:1024 lds
    s_add_u32 s70, s70, 6144
    buffer_load_dwordx4 v9, s[36:39], s70 offen offset:2048 lds
    s_add_u32 s70, s70, 6144
    buffer_load_dwordx4 v9, s[36:39], s70 offen offset:3072 lds
    s_bfe_u32 s70, s10, 0x40014
    s_add_u32 s70, s70, s65
    s_mul_i32 s70, s70, 28672
    s_lshl1_add_u32 m0, s64, 131072
    s_nop 0
    buffer_load_dwordx4 v9, s[36:39], s70 offen offset:0 lds
    s_add_u32 s70, s70, 6144
    buffer_load_dwordx4 v9, s[36:39], s70 offen offset:1024 lds
    s_add_u32 s70, s70, 6144
    buffer_load_dwordx4 v9, s[36:39], s70 offen offset:2048 lds
    s_add_u32 s70, s70, 6144
    buffer_load_dwordx4 v9, s[36:39], s70 offen offset:3072 lds
    s_waitcnt vmcnt(24)
    ds_read_b64_tr_b16 v[112:113], v10 offset:0
    ds_read_b64_tr_b16 v[114:115], v10 offset:1024
    ds_read_b64_tr_b16 v[116:117], v11 offset:0
    ds_read_b64_tr_b16 v[118:119], v11 offset:1024
    ds_read_b64_tr_b16 v[120:121], v10 offset:2048
    ds_read_b64_tr_b16 v[122:123], v10 offset:3072
    ds_read_b64_tr_b16 v[124:125], v11 offset:2048
    ds_read_b64_tr_b16 v[126:127], v11 offset:3072
    s_waitcnt vmcnt(20)
    ds_read_b64_tr_b16 v[128:129], v10 offset:49152
    ds_read_b64_tr_b16 v[130:131], v10 offset:50176
    ds_read_b64_tr_b16 v[132:133], v11 offset:49152
    ds_read_b64_tr_b16 v[134:135], v11 offset:50176
    ds_read_b64_tr_b16 v[136:137], v10 offset:51200
    ds_read_b64_tr_b16 v[138:139], v10 offset:52224
    ds_read_b64_tr_b16 v[140:141], v11 offset:51200
    ds_read_b64_tr_b16 v[142:143], v11 offset:52224
    s_waitcnt vmcnt(16) lgkmcnt(0)
    s_barrier
    s_bfe_u32 s70, s58, 0x40014
    s_mul_i32 s70, s70, 229376
    s_add_u32 s71, s70, 29440
    s_add_u32 s70, s70, 1792
    s_add_u32 m0, s64, 0
    s_nop 0
    buffer_load_dwordx4 v7, s[28:31], s70 offen offset:0 lds
    buffer_load_dwordx4 v7, s[28:31], s71 offen offset:1024 lds
    s_add_u32 m0, s64, 8192
    s_nop 0
    buffer_load_dwordx4 v8, s[32:35], s70 offen offset:0 lds
    buffer_load_dwordx4 v8, s[32:35], s71 offen offset:1024 lds
    s_bfe_u32 s70, s58, 0x40018
    s_mul_i32 s70, s70, 229376
    s_add_u32 s71, s70, 29440
    s_add_u32 s70, s70, 1792
    s_add_u32 m0, s64, 16384
    s_nop 0
    buffer_load_dwordx4 v7, s[28:31], s70 offen offset:0 lds
    buffer_load_dwordx4 v7, s[28:31], s71 offen offset:1024 lds
    s_add_u32 m0, s64, 24576
    s_nop 0
    buffer_load_dwordx4 v8, s[32:35], s70 offen offset:0 lds
    buffer_load_dwordx4 v8, s[32:35], s71 offen offset:1024 lds
    s_bfe_u32 s70, s10, 0x40018
    s_add_u32 s70, s70, s65
    s_mul_i32 s70, s70, 28672
    s_lshl1_add_u32 m0, s64, 147456
    s_nop 0
    buffer_load_dwordx4 v9, s[36:39], s70 offen offset:0 lds
    s_add_u32 s70, s70, 6144
    buffer_load_dwordx4 v9, s[36:39], s70 offen offset:1024 lds
    s_add_u32 s70, s70, 6144
    buffer_load_dwordx4 v9, s[36:39], s70 offen offset:2048 lds
    s_add_u32 s70, s70, 6144
    buffer_load_dwordx4 v9, s[36:39], s70 offen offset:3072 lds
    s_bfe_u32 s70, s6, 0x80000
    s_mul_i32 s70, s70, 28672
    s_lshl1_add_u32 m0, s64, 98304
    s_add_u32 s70, s70, 802816
    buffer_load_dwordx4 v9, s[36:39], s70 offen offset:0 lds
    s_add_u32 s70, s70, 6144
    buffer_load_dwordx4 v9, s[36:39], s70 offen offset:1024 lds
    s_add_u32 s70, s70, 6144
    buffer_load_dwordx4 v9, s[36:39], s70 offen offset:2048 lds
    s_add_u32 s70, s70, 6144
    buffer_load_dwordx4 v9, s[36:39], s70 offen offset:3072 lds
    s_waitcnt vmcnt(20)
    ds_read_b64_tr_b16 v[144:145], v10 offset:16384
    ds_read_b64_tr_b16 v[146:147], v10 offset:17408
    ds_read_b64_tr_b16 v[148:149], v11 offset:16384
    ds_read_b64_tr_b16 v[150:151], v11 offset:17408
    ds_read_b64_tr_b16 v[152:153], v10 offset:18432
    ds_read_b64_tr_b16 v[154:155], v10 offset:19456
    ds_read_b64_tr_b16 v[156:157], v11 offset:18432
    ds_read_b64_tr_b16 v[158:159], v11 offset:19456
    s_waitcnt lgkmcnt(0)
    s_barrier
    s_bfe_u32 s70, s6, 0x80008
    s_mul_i32 s70, s70, 28672
    s_lshl1_add_u32 m0, s64, 114688
    s_add_u32 s70, s70, 802816
    buffer_load_dwordx4 v9, s[36:39], s70 offen offset:0 lds
    s_add_u32 s70, s70, 6144
    buffer_load_dwordx4 v9, s[36:39], s70 offen offset:1024 lds
    s_add_u32 s70, s70, 6144
    buffer_load_dwordx4 v9, s[36:39], s70 offen offset:2048 lds
    s_add_u32 s70, s70, 6144
    buffer_load_dwordx4 v9, s[36:39], s70 offen offset:3072 lds
    s_waitcnt vmcnt(20)
    ds_read_b64_tr_b16 v[160:161], v10 offset:32768
    ds_read_b64_tr_b16 v[162:163], v10 offset:33792
    ds_read_b64_tr_b16 v[164:165], v11 offset:32768
    ds_read_b64_tr_b16 v[166:167], v11 offset:33792
    ds_read_b64_tr_b16 v[168:169], v10 offset:34816
    ds_read_b64_tr_b16 v[170:171], v10 offset:35840
    ds_read_b64_tr_b16 v[172:173], v11 offset:34816
    ds_read_b64_tr_b16 v[174:175], v11 offset:35840
    s_waitcnt lgkmcnt(0)
    s_bfe_u32 s70, s6, 0x80010
    s_mul_i32 s70, s70, 28672
    s_lshl1_add_u32 m0, s64, 131072
    s_add_u32 s70, s70, 802816
    buffer_load_dwordx4 v9, s[36:39], s70 offen offset:0 lds
    s_add_u32 s70, s70, 6144
    buffer_load_dwordx4 v9, s[36:39], s70 offen offset:1024 lds
    s_add_u32 s70, s70, 6144
    buffer_load_dwordx4 v9, s[36:39], s70 offen offset:2048 lds
    s_add_u32 s70, s70, 6144
    buffer_load_dwordx4 v9, s[36:39], s70 offen offset:3072 lds
    s_bfe_u32 s70, s7, 0x80000
    s_mul_i32 s70, s70, 28672
    s_lshl1_add_u32 m0, s64, 32768
    s_add_u32 s70, s70, 802816
    buffer_load_dwordx4 v9, s[36:39], s70 offen offset:0 lds
    s_add_u32 s70, s70, 6144
    buffer_load_dwordx4 v9, s[36:39], s70 offen offset:1024 lds
    s_add_u32 s70, s70, 6144
    buffer_load_dwordx4 v9, s[36:39], s70 offen offset:2048 lds
    s_add_u32 s70, s70, 6144
    buffer_load_dwordx4 v9, s[36:39], s70 offen offset:3072 lds
    buffer_load_dword v12, v6, s[40:43], s8 offen offset:8 sc1
    s_waitcnt vmcnt(17)
    ds_read_b64_tr_b16 v[176:177], v10 offset:49152
    ds_read_b64_tr_b16 v[178:179], v10 offset:50176
    ds_read_b64_tr_b16 v[180:181], v11 offset:49152
    ds_read_b64_tr_b16 v[182:183], v11 offset:50176
    ds_read_b64_tr_b16 v[184:185], v10 offset:51200
    ds_read_b64_tr_b16 v[186:187], v10 offset:52224
    ds_read_b64_tr_b16 v[188:189], v11 offset:51200
    ds_read_b64_tr_b16 v[190:191], v11 offset:52224
    s_waitcnt lgkmcnt(0)
    s_bfe_u32 s70, s6, 0x80018
    s_mul_i32 s70, s70, 28672
    s_lshl1_add_u32 m0, s64, 147456
    s_add_u32 s70, s70, 802816
    buffer_load_dwordx4 v9, s[36:39], s70 offen offset:0 lds
    s_add_u32 s70, s70, 6144
    buffer_load_dwordx4 v9, s[36:39], s70 offen offset:1024 lds
    s_add_u32 s70, s70, 6144
    buffer_load_dwordx4 v9, s[36:39], s70 offen offset:2048 lds
    s_add_u32 s70, s70, 6144
    buffer_load_dwordx4 v9, s[36:39], s70 offen offset:3072 lds
    s_waitcnt vmcnt(9)
    s_barrier
    s_lshl_b32 s66, s53, 16
    s_add_u32 s72, s11, 1835008
    s_add_u32 s11, s11, s66
    s_waitcnt vmcnt(4)
    v_cmp_ne_u32 vcc, s59, v12
    s_cbranch_vccnz spin_20
ok_19:
    s_bfe_u32 s70, s10, 0x40000
    s_add_u32 s70, s70, s65
    s_lshl_b32 s70, s70, 11
    s_add_u32 s70, s70, s62
    buffer_load_dwordx4 v[192:195], v1, s[40:43], s70 offen offset:0 sc1
    buffer_load_dwordx4 v[200:203], v1, s[40:43], s70 offen offset:1024 sc1
    s_add_u32 s70, s70, 114688
    buffer_load_dwordx4 v[196:199], v1, s[40:43], s70 offen offset:0 sc1
    buffer_load_dwordx4 v[204:207], v1, s[40:43], s70 offen offset:1024 sc1
    s_bfe_u32 s70, s10, 0x40004
    s_add_u32 s70, s70, s65
    s_lshl_b32 s70, s70, 11
    s_add_u32 s70, s70, s62
    buffer_load_dwordx4 v[208:211], v1, s[40:43], s70 offen offset:0 sc1
    buffer_load_dwordx4 v[216:219], v1, s[40:43], s70 offen offset:1024 sc1
    s_add_u32 s70, s70, 114688
    buffer_load_dwordx4 v[212:215], v1, s[40:43], s70 offen offset:0 sc1
    buffer_load_dwordx4 v[220:223], v1, s[40:43], s70 offen offset:1024 sc1
    s_bfe_u32 s70, s10, 0x40008
    s_add_u32 s70, s70, s65
    s_lshl_b32 s70, s70, 11
    s_add_u32 s70, s70, s62
    buffer_load_dwordx4 v[224:227], v1, s[40:43], s70 offen offset:0 sc1
    buffer_load_dwordx4 v[232:235], v1, s[40:43], s70 offen offset:1024 sc1
    s_add_u32 s70, s70, 114688
    buffer_load_dwordx4 v[228:231], v1, s[40:43], s70 offen offset:0 sc1
    buffer_load_dwordx4 v[236:239], v1, s[40:43], s70 offen offset:1024 sc1
    s_waitcnt vmcnt(11)
    v_mfma_f32_32x32x16_bf16 v[16:31], v[80:83], v[192:195], 0
    v_bfe_u32 v7, v1, 4, 5
    s_lshl_b32 s66, s57, 6
    v_add_u32 v7, s66, v7
    v_cvt_f32_u32 v7, v7
    v_add_f32 v8, 0x42000000, v7
    v_mul_f32 v7, 0x3b124925, v7
    v_mul_f32 v8, 0x3b124925, v8
    v_lshrrev_b32 v12, 9, v1
    s_waitcnt vmcnt(9)
    v_mfma_f32_32x32x16_bf16 v[48:63], v[80:83], v[196:199], 0
    s_lshl_b32 s66, s53, 3
    v_lshl_add_u32 v12, v12, 2, s66
    v_cmp_eq_u32 vcc, 0, v12
    v_cvt_f32_u32 v12, v12
    v_mul_f32 v13, v12, v8
    v_mul_f32 v12, v12, v7
    v_cndmask_b32 v0, 1.0, 0.5, vcc
    v_mfma_f32_32x32x16_bf16 v[32:47], v[84:87], v[192:195], 0
    v_mfma_f32_32x32x16_bf16 v[64:79], v[84:87], v[196:199], 0
    v_mfma_f32_32x32x16_bf16 v[16:31], v[88:91], v[200:203], v[16:31]
    s_waitcnt vmcnt(8)
    v_mfma_f32_32x32x16_bf16 v[48:63], v[88:91], v[204:207], v[48:63]
    v_mfma_f32_32x32x16_bf16 v[32:47], v[92:95], v[200:203], v[32:47]
    v_mfma_f32_32x32x16_bf16 v[64:79], v[92:95], v[204:207], v[64:79]
    s_barrier
    s_setprio 1
    s_bfe_u32 s70, s10, 0x4000c
    s_add_u32 s70, s70, s65
    s_lshl_b32 s70, s70, 11
    s_add_u32 s70, s70, s62
    buffer_load_dwordx4 v[240:243], v1, s[40:43], s70 offen offset:0 sc1
    buffer_load_dwordx4 v[248:251], v1, s[40:43], s70 offen offset:1024 sc1
    s_add_u32 s70, s70, 114688
    buffer_load_dwordx4 v[244:247], v1, s[40:43], s70 offen offset:0 sc1
    buffer_load_dwordx4 v[252:255], v1, s[40:43], s70 offen offset:1024 sc1
    s_bfe_u32 s70, s10, 0x40010
    s_add_u32 s70, s70, s65
    s_lshl_b32 s70, s70, 11
    s_add_u32 s70, s70, s62
    buffer_load_dwordx4 v[192:195], v1, s[40:43], s70 offen offset:0 sc1
    buffer_load_dwordx4 v[200:203], v1, s[40:43], s70 offen offset:1024 sc1
    s_add_u32 s70, s70, 114688
    buffer_load_dwordx4 v[196:199], v1, s[40:43], s70 offen offset:0 sc1
    buffer_load_dwordx4 v[204:207], v1, s[40:43], s70 offen offset:1024 sc1
    s_waitcnt vmcnt(15)
    v_mfma_f32_32x32x16_bf16 v[16:31], v[96:99], v[208:211], v[16:31]
    s_waitcnt vmcnt(13)
    v_mfma_f32_32x32x16_bf16 v[48:63], v[96:99], v[212:215], v[48:63]
    v_mfma_f32_32x32x16_bf16 v[32:47], v[100:103], v[208:211], v[32:47]
    v_mfma_f32_32x32x16_bf16 v[64:79], v[100:103], v[212:215], v[64:79]
    v_mfma_f32_32x32x16_bf16 v[16:31], v[104:107], v[216:219], v[16:31]
    s_waitcnt vmcnt(12)
    v_mfma_f32_32x32x16_bf16 v[48:63], v[104:107], v[220:223], v[48:63]
    v_mfma_f32_32x32x16_bf16 v[32:47], v[108:111], v[216:219], v[32:47]
    v_mfma_f32_32x32x16_bf16 v[64:79], v[108:111], v[220:223], v[64:79]
    v_mul_f32 v6, 0x42000000, v7
    v_cos_f32 v6, v6
    v_fmamk_f32 v84, v7, 0x42800000, v12
    v_sin_f32 v85, v84
    v_cos_f32 v84, v84
    s_bfe_u32 s70, s10, 0x40014
    s_add_u32 s70, s70, s65
    s_lshl_b32 s70, s70, 11
    s_add_u32 s70, s70, s62
    buffer_load_dwordx4 v[208:211], v1, s[40:43], s70 offen offset:0 sc1
    buffer_load_dwordx4 v[216:219], v1, s[40:43], s70 offen offset:1024 sc1
    s_add_u32 s70, s70, 114688
    buffer_load_dwordx4 v[212:215], v1, s[40:43], s70 offen offset:0 sc1
    buffer_load_dwordx4 v[220:223], v1, s[40:43], s70 offen offset:1024 sc1
    s_waitcnt vmcnt(15)
    v_mfma_f32_32x32x16_bf16 v[16:31], v[112:115], v[224:227], v[16:31]
    v_fmamk_f32 v86, v7, 0x42c00000, v12
    v_sin_f32 v87, v86
    v_cos_f32 v86, v86
    v_fmamk_f32 v98, v7, 0x42820000, v12
    v_sin_f32 v99, v98
    s_waitcnt vmcnt(13)
    v_mfma_f32_32x32x16_bf16 v[48:63], v[112:115], v[228:231], v[48:63]
    v_cos_f32 v98, v98
    v_fmamk_f32 v100, v7, 0x42c20000, v12
    v_sin_f32 v101, v100
    v_cos_f32 v100, v100
    v_mfma_f32_32x32x16_bf16 v[32:47], v[116:119], v[224:227], v[32:47]
    v_add_f32 v6, v6, v6
    v_fma_f32 v82, v6, v84, -v86
    v_fma_f32 v83, v6, v85, -v87
    v_fma_f32 v96, v6, v98, -v100
    v_fma_f32 v97, v6, v99, -v101
    v_fma_f32 v88, v6, v86, -v84
    v_fma_f32 v89, v6, v87, -v85
    v_mfma_f32_32x32x16_bf16 v[64:79], v[116:119], v[228:231], v[64:79]
    v_fma_f32 v102, v6, v100, -v98
    v_fma_f32 v103, v6, v101, -v99
    v_fma_f32 v80, v6, v82, -v84
    v_fma_f32 v81, v6, v83, -v85
    v_fma_f32 v94, v6, v96, -v98
    v_fma_f32 v95, v6, v97, -v99
    v_fma_f32 v90, v6, v88, -v86
    v_mfma_f32_32x32x16_bf16 v[16:31], v[120:123], v[232:235], v[16:31]
    v_fma_f32 v91, v6, v89, -v87
    v_fma_f32 v104, v6, v102, -v100
    v_fma_f32 v105, v6, v103, -v101
    v_fma_f32 v92, v6, v90, -v88
    v_fma_f32 v93, v6, v91, -v89
    v_fma_f32 v106, v6, v104, -v102
    v_fma_f32 v107, v6, v105, -v103
    s_waitcnt vmcnt(12)
    v_mfma_f32_32x32x16_bf16 v[48:63], v[120:123], v[236:239], v[48:63]
    v_mul_f32 v80, v80, v0
    v_cvt_pk_bf16_f32 v108, v80, v81
    v_cvt_pk_bf16_f32 v109, v94, v95
    v_mfma_f32_32x32x16_bf16 v[32:47], v[124:127], v[232:235], v[32:47]
    v_mfma_f32_32x32x16_bf16 v[64:79], v[124:127], v[236:239], v[64:79]
    v_cvt_pk_bf16_f32 v112, v82, v83
    v_cvt_pk_bf16_f32 v113, v96, v97
    v_cvt_pk_bf16_f32 v116, v84, v85
    v_cvt_pk_bf16_f32 v117, v98, v99
    v_cvt_pk_bf16_f32 v120, v86, v87
    v_cvt_pk_bf16_f32 v121, v100, v101
    v_cvt_pk_bf16_f32 v124, v88, v89
    s_bfe_u32 s70, s10, 0x40018
    s_add_u32 s70, s70, s65
    s_lshl_b32 s70, s70, 11
    s_add_u32 s70, s70, s62
    buffer_load_dwordx4 v[224:227], v1, s[40:43], s70 offen offset:0 sc1
    buffer_load_dwordx4 v[232:235], v1, s[40:43], s70 offen offset:1024 sc1
    s_add_u32 s70, s70, 114688
    buffer_load_dwordx4 v[228:231], v1, s[40:43], s70 offen offset:0 sc1
    buffer_load_dwordx4 v[236:239], v1, s[40:43], s70 offen offset:1024 sc1
    s_waitcnt vmcnt(15)
    v_mfma_f32_32x32x16_bf16 v[16:31], v[128:131], v[240:243], v[16:31]
    v_cvt_pk_bf16_f32 v125, v102, v103
    s_waitcnt vmcnt(13)
    v_mfma_f32_32x32x16_bf16 v[48:63], v[128:131], v[244:247], v[48:63]
    v_mfma_f32_32x32x16_bf16 v[32:47], v[132:135], v[240:243], v[32:47]
    v_mfma_f32_32x32x16_bf16 v[64:79], v[132:135], v[244:247], v[64:79]
    v_mfma_f32_32x32x16_bf16 v[16:31], v[136:139], v[248:251], v[16:31]
    s_waitcnt vmcnt(12)
    v_mfma_f32_32x32x16_bf16 v[48:63], v[136:139], v[252:255], v[48:63]
    v_mfma_f32_32x32x16_bf16 v[32:47], v[140:143], v[248:251], v[32:47]
    v_mfma_f32_32x32x16_bf16 v[64:79], v[140:143], v[252:255], v[64:79]
    v_cvt_pk_bf16_f32 v128, v90, v91
    v_cvt_pk_bf16_f32 v129, v104, v105
    v_cvt_pk_bf16_f32 v132, v92, v93
    v_cvt_pk_bf16_f32 v133, v106, v107
    v_fmamk_f32 v84, v7, 0x42840000, v12
    v_sin_f32 v85, v84
    s_waitcnt vmcnt(11)
    v_mfma_f32_32x32x16_bf16 v[16:31], v[144:147], v[192:195], v[16:31]
    v_cos_f32 v84, v84
    v_fmamk_f32 v86, v7, 0x42c40000, v12
    v_sin_f32 v87, v86
    v_cos_f32 v86, v86
    s_waitcnt vmcnt(9)
    v_mfma_f32_32x32x16_bf16 v[48:63], v[144:147], v[196:199], v[48:63]
    v_fmamk_f32 v98, v7, 0x42860000, v12
    v_sin_f32 v99, v98
    v_cos_f32 v98, v98
    v_fmamk_f32 v100, v7, 0x42c60000, v12
    v_sin_f32 v101, v100
    v_mfma_f32_32x32x16_bf16 v[32:47], v[148:151], v[192:195], v[32:47]
    v_cos_f32 v100, v100
    v_fma_f32 v82, v6, v84, -v86
    v_fma_f32 v83, v6, v85, -v87
    v_fma_f32 v96, v6, v98, -v100
    v_fma_f32 v97, v6, v99, -v101
    v_fma_f32 v88, v6, v86, -v84
    v_mfma_f32_32x32x16_bf16 v[64:79], v[148:151], v[196:199], v[64:79]
    v_fma_f32 v89, v6, v87, -v85
    v_fma_f32 v102, v6, v100, -v98
    v_fma_f32 v103, v6, v101, -v99
    v_fma_f32 v80, v6, v82, -v84
    v_fma_f32 v81, v6, v83, -v85
    v_fma_f32 v94, v6, v96, -v98
    v_fma_f32 v95, v6, v97, -v99
    v_mfma_f32_32x32x16_bf16 v[16:31], v[152:155], v[200:203], v[16:31]
    v_fma_f32 v90, v6, v88, -v86
    v_fma_f32 v91, v6, v89, -v87
    v_fma_f32 v104, v6, v102, -v100
    v_fma_f32 v105, v6, v103, -v101
    v_fma_f32 v92, v6, v90, -v88
    v_fma_f32 v93, v6, v91, -v89
    v_fma_f32 v106, v6, v104, -v102
    s_waitcnt vmcnt(8)
    v_mfma_f32_32x32x16_bf16 v[48:63], v[152:155], v[204:207], v[48:63]
    v_fma_f32 v107, v6, v105, -v103
    v_cvt_pk_bf16_f32 v110, v80, v81
    v_cvt_pk_bf16_f32 v111, v94, v95
    v_cvt_pk_bf16_f32 v114, v82, v83
    v_cvt_pk_bf16_f32 v115, v96, v97
    v_cvt_pk_bf16_f32 v118, v84, v85
    v_cvt_pk_bf16_f32 v119, v98, v99
    v_mfma_f32_32x32x16_bf16 v[32:47], v[156:159], v[200:203], v[32:47]
    v_cvt_pk_bf16_f32 v122, v86, v87
    v_cvt_pk_bf16_f32 v123, v100, v101
    v_cvt_pk_bf16_f32 v126, v88, v89
    v_cvt_pk_bf16_f32 v127, v102, v103
    v_cvt_pk_bf16_f32 v130, v90, v91
    v_cvt_pk_bf16_f32 v131, v104, v105
    v_cvt_pk_bf16_f32 v134, v92, v93
    v_mfma_f32_32x32x16_bf16 v[64:79], v[156:159], v[204:207], v[64:79]
    v_cvt_pk_bf16_f32 v135, v106, v107
    v_mul_f32 v6, 0x42000000, v8
    v_cos_f32 v6, v6
    v_fmamk_f32 v84, v8, 0x42800000, v13
    v_sin_f32 v85, v84
    s_add_u32 s70, s11, 0
    buffer_load_dwordx4 v[148:151], v1, s[40:43], s70 offen offset:0 sc1
    s_add_u32 s70, s11, 262144
    buffer_load_dwordx4 v[152:155], v1, s[40:43], s70 offen offset:0 sc1
    s_add_u32 s70, s11, 524288
    buffer_load_dwordx4 v[156:159], v1, s[40:43], s70 offen offset:0 sc1
    s_add_u32 s70, s11, 786432
    buffer_load_dwordx4 v[192:195], v1, s[40:43], s70 offen offset:0 sc1
    s_add_u32 s70, s11, 1048576
    buffer_load_dwordx4 v[196:199], v1, s[40:43], s70 offen offset:0 sc1
    s_add_u32 s70, s11, 1310720
    buffer_load_dwordx4 v[200:203], v1, s[40:43], s70 offen offset:0 sc1
    s_add_u32 s70, s11, 1572864
    buffer_load_dwordx4 v[204:207], v1, s[40:43], s70 offen offset:0 sc1
    s_waitcnt vmcnt(14)
    v_mfma_f32_32x32x16_bf16 v[16:31], v[160:163], v[208:211], v[16:31]
    v_cos_f32 v84, v84
    v_fmamk_f32 v86, v8, 0x42c00000, v13
    v_sin_f32 v87, v86
    v_cos_f32 v86, v86
    s_waitcnt vmcnt(12)
    v_mfma_f32_32x32x16_bf16 v[48:63], v[160:163], v[212:215], v[48:63]
    v_fmamk_f32 v98, v8, 0x42820000, v13
    v_sin_f32 v99, v98
    v_cos_f32 v98, v98
    v_fmamk_f32 v100, v8, 0x42c20000, v13
    v_sin_f32 v101, v100
    v_mfma_f32_32x32x16_bf16 v[32:47], v[164:167], v[208:211], v[32:47]
    v_cos_f32 v100, v100
    v_add_f32 v6, v6, v6
    v_fma_f32 v82, v6, v84, -v86
    v_fma_f32 v83, v6, v85, -v87
    v_fma_f32 v96, v6, v98, -v100
    v_fma_f32 v97, v6, v99, -v101
    v_mfma_f32_32x32x16_bf16 v[64:79], v[164:167], v[212:215], v[64:79]
    v_fma_f32 v88, v6, v86, -v84
    v_fma_f32 v89, v6, v87, -v85
    v_fma_f32 v102, v6, v100, -v98
    v_fma_f32 v103, v6, v101, -v99
    v_fma_f32 v80, v6, v82, -v84
    v_fma_f32 v81, v6, v83, -v85
    v_fma_f32 v94, v6, v96, -v98
    v_mfma_f32_32x32x16_bf16 v[16:31], v[168:171], v[216:219], v[16:31]
    v_fma_f32 v95, v6, v97, -v99
    v_fma_f32 v90, v6, v88, -v86
    v_fma_f32 v91, v6, v89, -v87
    v_fma_f32 v104, v6, v102, -v100
    v_fma_f32 v105, v6, v103, -v101
    v_fma_f32 v92, v6, v90, -v88
    v_fma_f32 v93, v6, v91, -v89
    s_waitcnt vmcnt(11)
    v_mfma_f32_32x32x16_bf16 v[48:63], v[168:171], v[220:223], v[48:63]
    v_fma_f32 v106, v6, v104, -v102
    v_fma_f32 v107, v6, v105, -v103
    v_mul_f32 v80, v80, v0
    v_cvt_pk_bf16_f32 v136, v80, v81
    v_cvt_pk_bf16_f32 v137, v94, v95
    v_cvt_pk_bf16_f32 v140, v82, v83
    v_cvt_pk_bf16_f32 v141, v96, v97
    v_mfma_f32_32x32x16_bf16 v[32:47], v[172:175], v[216:219], v[32:47]
    v_cvt_pk_bf16_f32 v240, v84, v85
    v_cvt_pk_bf16_f32 v241, v98, v99
    v_cvt_pk_bf16_f32 v244, v86, v87
    v_cvt_pk_bf16_f32 v245, v100, v101
    v_cvt_pk_bf16_f32 v248, v88, v89
    v_cvt_pk_bf16_f32 v249, v102, v103
    v_cvt_pk_bf16_f32 v252, v90, v91
    v_mfma_f32_32x32x16_bf16 v[64:79], v[172:175], v[220:223], v[64:79]
    v_cvt_pk_bf16_f32 v253, v104, v105
    v_cvt_pk_bf16_f32 v144, v92, v93
    v_cvt_pk_bf16_f32 v145, v106, v107
    v_fmamk_f32 v84, v8, 0x42840000, v13
    v_sin_f32 v85, v84
    v_cos_f32 v84, v84
    s_add_u32 s70, s11, 0
    buffer_load_dwordx4 v[160:163], v1, s[40:43], s70 offen offset:1024 sc1
    s_add_u32 s70, s11, 262144
    buffer_load_dwordx4 v[164:167], v1, s[40:43], s70 offen offset:1024 sc1
    s_add_u32 s70, s11, 524288
    buffer_load_dwordx4 v[168:171], v1, s[40:43], s70 offen offset:1024 sc1
    s_add_u32 s70, s11, 786432
    buffer_load_dwordx4 v[172:175], v1, s[40:43], s70 offen offset:1024 sc1
    s_add_u32 s70, s11, 1048576
    buffer_load_dwordx4 v[208:211], v1, s[40:43], s70 offen offset:1024 sc1
    s_add_u32 s70, s11, 1310720
    buffer_load_dwordx4 v[212:215], v1, s[40:43], s70 offen offset:1024 sc1
    s_add_u32 s70, s11, 1572864
    buffer_load_dwordx4 v[216:219], v1, s[40:43], s70 offen offset:1024 sc1
    s_waitcnt vmcnt(17)
    v_mfma_f32_32x32x16_bf16 v[16:31], v[176:179], v[224:227], v[16:31]
    v_fmamk_f32 v86, v8, 0x42c40000, v13
    v_sin_f32 v87, v86
    v_cos_f32 v86, v86
    v_fmamk_f32 v98, v8, 0x42860000, v13
    v_sin_f32 v99, v98
    s_waitcnt vmcnt(15)
    v_mfma_f32_32x32x16_bf16 v[48:63], v[176:179], v[228:231], v[48:63]
    v_cos_f32 v98, v98
    v_fmamk_f32 v100, v8, 0x42c60000, v13
    v_sin_f32 v101, v100
    v_cos_f32 v100, v100
    v_mfma_f32_32x32x16_bf16 v[32:47], v[180:183], v[224:227], v[32:47]
    v_fma_f32 v82, v6, v84, -v86
    v_fma_f32 v83, v6, v85, -v87
    v_fma_f32 v96, v6, v98, -v100
    v_fma_f32 v97, v6, v99, -v101
    v_fma_f32 v88, v6, v86, -v84
    v_fma_f32 v89, v6, v87, -v85
    v_fma_f32 v102, v6, v100, -v98
    v_mfma_f32_32x32x16_bf16 v[64:79], v[180:183], v[228:231], v[64:79]
    v_fma_f32 v103, v6, v101, -v99
    v_fma_f32 v80, v6, v82, -v84
    v_fma_f32 v81, v6, v83, -v85
    v_fma_f32 v94, v6, v96, -v98
    v_fma_f32 v95, v6, v97, -v99
    v_fma_f32 v90, v6, v88, -v86
    v_fma_f32 v91, v6, v89, -v87
    v_mfma_f32_32x32x16_bf16 v[16:31], v[184:187], v[232:235], v[16:31]
    v_fma_f32 v104, v6, v102, -v100
    v_fma_f32 v105, v6, v103, -v101
    v_fma_f32 v92, v6, v90, -v88
    v_fma_f32 v93, v6, v91, -v89
    v_fma_f32 v106, v6, v104, -v102
    v_fma_f32 v107, v6, v105, -v103
    v_cvt_pk_bf16_f32 v138, v80, v81
    s_waitcnt vmcnt(14)
    v_mfma_f32_32x32x16_bf16 v[48:63], v[184:187], v[236:239], v[48:63]
    v_cvt_pk_bf16_f32 v139, v94, v95
    v_cvt_pk_bf16_f32 v142, v82, v83
    v_cvt_pk_bf16_f32 v143, v96, v97
    v_cvt_pk_bf16_f32 v242, v84, v85
    v_cvt_pk_bf16_f32 v243, v98, v99
    v_cvt_pk_bf16_f32 v246, v86, v87
    v_cvt_pk_bf16_f32 v247, v100, v101
    v_mfma_f32_32x32x16_bf16 v[32:47], v[188:191], v[232:235], v[32:47]
    v_cvt_pk_bf16_f32 v250, v88, v89
    v_cvt_pk_bf16_f32 v251, v102, v103
    v_cvt_pk_bf16_f32 v254, v90, v91
    v_cvt_pk_bf16_f32 v255, v104, v105
    v_cvt_pk_bf16_f32 v146, v92, v93
    v_cvt_pk_bf16_f32 v147, v106, v107
    v_mfma_f32_32x32x16_bf16 v[64:79], v[188:191], v[236:239], v[64:79]
    s_mov_b64 s[44:45], s[18:19]
    s_mov_b32 s46, 0x1c0000
    s_mov_b32 s47, 0x20000
    s_mov_b64 s[24:25], s[4:5]
    s_mov_b32 s26, 0x1c0000
    s_mov_b32 s27, 0x20000
    s_and_b32 s9, s60, 0x39
    s_lshl2_add_u32 s9, s56, s9
    s_mul_i32 s9, s9, 896
    s_lshl_b32 s67, s57, 7
    s_add_u32 s9, s9, s67
    s_mul_i32 s66, s53, 12
    s_and_b32 s66, s66, 0x14
    s_cmp_eq_u32 s53, 3
    s_cselect_b32 s66, 0x14, s66
    v_bfe_u32 v225, v1, 7, 1
    v_bfe_u32 v228, v1, 8, 1
    v_lshl_add_u32 v225, v228, 3, v225
    v_lshrrev_b32 v228, 9, v1
    v_lshl_add_u32 v225, v228, 1, v225
    v_add_u32 v225, s66, v225
    v_mul_u32_u24 v224, 57344, v225
    v_and_b32 v228, 0x70, v1
    v_add_u32 v224, v224, v228
    v_lshlrev_b32 v225, 4, v225
    buffer_load_dwordx4 v[180:183], v224, s[24:27], s9 offen offset:1792
    buffer_load_dword v222, v225, s[40:43], s72 offen offset:1024 sc1
    v_bfe_u32 v228, v1, 6, 1
    v_lshlrev_b32 v228, 14, v228
    v_and_b32 v15, 0x30, v1
    v_lshl_add_u32 v228, v15, 6, v228
    v_lshlrev_b32 v15, 1, v15
    v_xor_b32 v15, v15, v225
    v_add_u32 v228, v228, v15
    v_xor_b32 v229, 528, v228
    v_add_u32 v230, 81920, v228
    v_add_u32 v231, 81920, v229
    s_waitcnt vmcnt(13)
    v_max3_u32 v15, v151, v155, v159
    s_waitcnt vmcnt(12)
    v_max_u32 v15, v15, v195
    v_cmp_eq_u32 vcc, -1, v15
    s_cbranch_vccnz spin_22
ok_21:
    v_mfma_f32_32x32x16_bf16 v[16:31], v[108:111], v[148:151], v[16:31]
    v_mfma_f32_32x32x16_bf16 v[16:31], v[112:115], v[152:155], v[16:31]
    v_mfma_f32_32x32x16_bf16 v[16:31], v[116:119], v[156:159], v[16:31]
    v_mfma_f32_32x32x16_bf16 v[16:31], v[120:123], v[192:195], v[16:31]
    s_waitcnt vmcnt(9)
    v_max3_u32 v15, v199, v203, v207
    v_max_u32 v15, v15, v207
    v_cmp_eq_u32 vcc, -1, v15
    s_cbranch_vccnz spin_24
ok_23:
    v_mfma_f32_32x32x16_bf16 v[16:31], v[124:127], v[196:199], v[16:31]
    v_mfma_f32_32x32x16_bf16 v[16:31], v[128:131], v[200:203], v[16:31]
    v_mfma_f32_32x32x16_bf16 v[16:31], v[132:135], v[204:207], v[16:31]
    v_mfma_f32_32x32x16_bf16 v[32:47], v[136:139], v[148:151], v[32:47]
    v_mfma_f32_32x32x16_bf16 v[32:47], v[140:143], v[152:155], v[32:47]
    s_nop 9
    ds_write_b128 v2, v[16:19] offset:0
    v_mfma_f32_32x32x16_bf16 v[32:47], v[240:243], v[156:159], v[32:47]
    ds_write_b128 v3, v[20:23] offset:1024
    v_mfma_f32_32x32x16_bf16 v[32:47], v[244:247], v[192:195], v[32:47]
    ds_write_b128 v4, v[24:27] offset:2048
    v_mfma_f32_32x32x16_bf16 v[32:47], v[248:251], v[196:199], v[32:47]
    ds_write_b128 v5, v[28:31] offset:3072
    v_mfma_f32_32x32x16_bf16 v[32:47], v[252:255], v[200:203], v[32:47]
    v_mfma_f32_32x32x16_bf16 v[32:47], v[144:147], v[204:207], v[32:47]
    s_waitcnt vmcnt(6)
    v_max3_u32 v15, v163, v167, v171
    s_waitcnt vmcnt(5)
    v_max_u32 v15, v15, v175
    v_cmp_eq_u32 vcc, -1, v15
    s_cbranch_vccnz spin_26
ok_25:
    v_mfma_f32_32x32x16_bf16 v[48:63], v[108:111], v[160:163], v[48:63]
    v_mfma_f32_32x32x16_bf16 v[48:63], v[112:115], v[164:167], v[48:63]
    s_nop 3
    ds_write_b128 v2, v[32:35] offset:16384
    v_mfma_f32_32x32x16_bf16 v[48:63], v[116:119], v[168:171], v[48:63]
    v_add_u32 v2, 81920, v2
    ds_write_b128 v3, v[36:39] offset:17408
    v_mfma_f32_32x32x16_bf16 v[48:63], v[120:123], v[172:175], v[48:63]
    v_add_u32 v3, 81920, v3
    ds_write_b128 v4, v[40:43] offset:18432
    s_waitcnt vmcnt(2)
    v_max3_u32 v15, v211, v215, v219
    v_max_u32 v15, v15, v219
    v_cmp_eq_u32 vcc, -1, v15
    s_cbranch_vccnz spin_28
ok_27:
    v_mfma_f32_32x32x16_bf16 v[48:63], v[124:127], v[208:211], v[48:63]
    v_add_u32 v4, 81920, v4
    ds_write_b128 v5, v[44:47] offset:19456
    v_mfma_f32_32x32x16_bf16 v[48:63], v[128:131], v[212:215], v[48:63]
    v_add_u32 v5, 81920, v5
    v_mfma_f32_32x32x16_bf16 v[48:63], v[132:135], v[216:219], v[48:63]
    v_mfma_f32_32x32x16_bf16 v[64:79], v[136:139], v[160:163], v[64:79]
    v_mfma_f32_32x32x16_bf16 v[64:79], v[140:143], v[164:167], v[64:79]
    s_nop 9
    ds_write_b128 v2, v[48:51] offset:0
    v_mfma_f32_32x32x16_bf16 v[64:79], v[240:243], v[168:171], v[64:79]
    ds_write_b128 v3, v[52:55] offset:1024
    v_mfma_f32_32x32x16_bf16 v[64:79], v[244:247], v[172:175], v[64:79]
    ds_write_b128 v4, v[56:59] offset:2048
    v_mfma_f32_32x32x16_bf16 v[64:79], v[248:251], v[208:211], v[64:79]
    ds_write_b128 v5, v[60:63] offset:3072
    v_mfma_f32_32x32x16_bf16 v[64:79], v[252:255], v[212:215], v[64:79]
    v_mfma_f32_32x32x16_bf16 v[64:79], v[144:147], v[216:219], v[64:79]
    s_waitcnt vmcnt(1)
    v_lshlrev_b32 v156, 16, v182
    v_and_b32 v157, 0xffff0000, v182
    v_lshlrev_b32 v158, 16, v183
    v_and_b32 v159, 0xffff0000, v183
    v_lshlrev_b32 v152, 16, v180
    v_and_b32 v153, 0xffff0000, v180
    v_lshlrev_b32 v154, 16, v181
    v_and_b32 v155, 0xffff0000, v181
    s_nop 2
    ds_write_b128 v2, v[64:67] offset:16384
    ds_write_b128 v3, v[68:71] offset:17408
    ds_write_b128 v4, v[72:75] offset:18432
    ds_write_b128 v5, v[76:79] offset:19456
    s_waitcnt vmcnt(0)
    v_cmp_eq_u32 vcc, -1, v222
    s_cbranch_vccnz spin_30
ok_29:
    v_lshlrev_b32 v222, 16, v222
    v_fma_f32 v152, v222, 0.5, v152
    v_fma_f32 v153, v222, -0.5, v153
    v_fma_f32 v154, v222, 0.5, v154
    v_fma_f32 v155, v222, -0.5, v155
    v_fma_f32 v156, v222, 0.5, v156
    v_fma_f32 v157, v222, -0.5, v157
    v_fma_f32 v158, v222, 0.5, v158
    v_fma_f32 v159, v222, -0.5, v159
    s_waitcnt lgkmcnt(0)
    s_barrier
    s_add_u32 s66, s2, s52
    s_cmp_lg_u32 s66, 36
    s_cbranch_scc1 noep_31
    s_mov_b32 s66, 4390912
    s_mov_b64 exec, 255
    buffer_store_dwordx4 v[12:15], v1, s[40:43], s66 offen sc1
    s_mov_b64 exec, -1
noep_31:
    s_setprio 0
    ds_read_b128 v[80:83], v228 offset:32768
    ds_read_b128 v[84:87], v228 offset:36864
    ds_read_b128 v[88:91], v228 offset:40960
    ds_read_b128 v[92:95], v228 offset:45056
    ds_read_b128 v[96:99], v230 offset:0
    ds_read_b128 v[100:103], v230 offset:4096
    ds_read_b128 v[104:107], v230 offset:8192
    ds_read_b128 v[108:111], v230 offset:12288
    ds_read_b128 v[112:115], v229 offset:32768
    ds_read_b128 v[116:119], v229 offset:36864
    ds_read_b128 v[120:123], v229 offset:40960
    ds_read_b128 v[124:127], v229 offset:45056
    ds_read_b128 v[128:131], v231 offset:0
    ds_read_b128 v[132:135], v231 offset:4096
    ds_read_b128 v[136:139], v231 offset:8192
    ds_read_b128 v[140:143], v231 offset:12288
    s_waitcnt lgkmcnt(14)
    v_pk_add_f32 v[80:81], v[80:81], v[84:85]
    v_pk_add_f32 v[82:83], v[82:83], v[86:87]
    v_pk_add_f32 v[152:153], v[152:153], v[80:81]
    v_pk_add_f32 v[154:155], v[154:155], v[82:83]
    s_waitcnt lgkmcnt(12)
    v_pk_add_f32 v[88:89], v[88:89], v[92:93]
    v_pk_add_f32 v[90:91], v[90:91], v[94:95]
    v_pk_add_f32 v[152:153], v[152:153], v[88:89]
    v_pk_add_f32 v[154:155], v[154:155], v[90:91]
    s_waitcnt lgkmcnt(10)
    v_pk_add_f32 v[96:97], v[96:97], v[100:101]
    v_pk_add_f32 v[98:99], v[98:99], v[102:103]
    v_pk_add_f32 v[152:153], v[152:153], v[96:97]
    v_pk_add_f32 v[154:155], v[154:155], v[98:99]
    s_waitcnt lgkmcnt(8)
    v_pk_add_f32 v[104:105], v[104:105], v[108:109]
    v_pk_add_f32 v[106:107], v[106:107], v[110:111]
    v_pk_add_f32 v[152:153], v[152:153], v[104:105]
    v_pk_add_f32 v[154:155], v[154:155], v[106:107]
    v_cvt_pk_bf16_f32 v152, v152, v153
    v_cvt_pk_bf16_f32 v153, v154, v155
    s_waitcnt lgkmcnt(6)
    v_pk_add_f32 v[112:113], v[112:113], v[116:117]
    v_pk_add_f32 v[114:115], v[114:115], v[118:119]
    v_pk_add_f32 v[156:157], v[156:157], v[112:113]
    v_pk_add_f32 v[158:159], v[158:159], v[114:115]
    s_waitcnt lgkmcnt(4)
    v_pk_add_f32 v[120:121], v[120:121], v[124:125]
    v_pk_add_f32 v[122:123], v[122:123], v[126:127]
    v_pk_add_f32 v[156:157], v[156:157], v[120:121]
    v_pk_add_f32 v[158:159], v[158:159], v[122:123]
    s_waitcnt lgkmcnt(2)
    v_pk_add_f32 v[128:129], v[128:129], v[132:133]
    v_pk_add_f32 v[130:131], v[130:131], v[134:135]
    v_pk_add_f32 v[156:157], v[156:157], v[128:129]
    v_pk_add_f32 v[158:159], v[158:159], v[130:131]
    s_waitcnt lgkmcnt(0)
    v_pk_add_f32 v[136:137], v[136:137], v[140:141]
    v_pk_add_f32 v[138:139], v[138:139], v[142:143]
    v_pk_add_f32 v[156:157], v[156:157], v[136:137]
    v_pk_add_f32 v[158:159], v[158:159], v[138:139]
    v_cvt_pk_bf16_f32 v154, v156, v157
    v_cvt_pk_bf16_f32 v155, v158, v159
    buffer_store_dwordx4 v[152:155], v224, s[44:47], s9 offen offset:1792 sc1
    s_endpgm
T_WG:
    s_lshr_b32 s66, s2, 1
    s_lshl_b32 s66, s66, 2
    s_and_b32 s53, s52, 3
    s_add_u32 s66, s66, s53
    s_lshl_b32 s66, s66, 1
    s_and_b32 s67, s2, 1
    s_add_u32 s66, s66, s67
    s_mul_i32 s66, s66, 7200
    s_add_u32 s67, s66, 4096
    s_lshl_b32 s64, s52, 13
    s_cmp_ge_u32 s52, 4
    s_waitcnt lgkmcnt(0)
    s_cselect_b32 s48, s8, s6
    s_cselect_b32 s49, s9, s7
    s_mov_b32 s50, 921600
    s_mov_b32 s51, 0x20000
    s_add_u32 m0, s64, 0
    s_nop 0
    buffer_load_dwordx4 v1, s[48:51], s66 offen offset:0 lds
    buffer_load_dwordx4 v1, s[48:51], s66 offen offset:1024 lds
    buffer_load_dwordx4 v1, s[48:51], s66 offen offset:2048 lds
    buffer_load_dwordx4 v1, s[48:51], s66 offen offset:3072 lds
    s_add_u32 m0, s64, 4096
    s_nop 0
    buffer_load_dwordx4 v1, s[48:51], s67 offen offset:0 lds
    buffer_load_dwordx4 v1, s[48:51], s67 offen offset:1024 lds
    buffer_load_dwordx4 v1, s[48:51], s67 offen offset:2048 lds
    s_mov_b64 exec, 3
    buffer_load_dwordx4 v1, s[48:51], s67 offen offset:3072 lds
    s_mov_b64 exec, -1
    s_add_u32 s70, s22, 0x430000
    s_addc_u32 s71, s23, 0
    s_load_dword s59, s[70:71], 8
    s_mov_b64 s[40:41], s[22:23]
    s_mov_b32 s42, 0xdd0000
    s_mov_b32 s43, 0x20000
    s_add_u32 s28, s22, 0x200000
    s_addc_u32 s29, s23, 0
    s_mov_b32 s30, 0x1c2000
    s_mov_b32 s31, 0x20000
    v_bfe_u32 v2, v1, 4, 5
    v_cvt_f32_u32 v2, v2
    v_lshrrev_b32 v3, 9, v1
    v_lshlrev_b32 v3, 2, v3
    s_lshl_b32 s66, s53, 3
    v_add_u32 v3, s66, v3
    v_cvt_f32_u32 v3, v3
    s_lshr_b32 s66, s52, 2
    v_cvt_f32_u32 v4, s66
    v_mul_f32 v5, 0x3d000000, v2
    v_fma_f32 v6, 0.5, v4, v3
    v_mul_f32 v6, v6, v5
    s_lshl_b32 s66, s52, 11
    s_add_u32 s66, s66, 65536
    v_add_u32 v7, s66, v1
    v_fmamk_f32 v24, v5, 0x00000000, v6
    v_sin_f32 v28, v24
    v_cos_f32 v24, v24
    v_fmamk_f32 v25, v5, 0x3f800000, v6
    v_sin_f32 v29, v25
    v_cos_f32 v25, v25
    v_fmamk_f32 v26, v5, 0x40000000, v6
    v_sin_f32 v30, v26
    v_cos_f32 v26, v26
    v_fmamk_f32 v27, v5, 0x40400000, v6
    v_sin_f32 v31, v27
    v_cos_f32 v27, v27
    v_cvt_pk_bf16_f32 v16, v24, v28
    v_cvt_pk_bf16_f32 v20, -v28, v24
    v_cvt_pk_bf16_f32 v17, v25, v29
    v_cvt_pk_bf16_f32 v21, -v29, v25
    v_cvt_pk_bf16_f32 v18, v26, v30
    v_cvt_pk_bf16_f32 v22, -v30, v26
    v_cvt_pk_bf16_f32 v19, v27, v31
    v_cvt_pk_bf16_f32 v23, -v31, v27
    ds_write_b128 v7, v[16:19] offset:24576
    ds_write_b128 v7, v[20:23] offset:25600
    v_fma_f32 v8, 0.5, v4, v2
    v_mul_f32 v8, 0x3a800000, v8
    v_mul_f32 v9, v8, v3
    v_fmamk_f32 v48, v8, 0x00000000, v9
    v_sin_f32 v52, v48
    v_cos_f32 v48, v48
    v_fmamk_f32 v49, v8, 0x3f800000, v9
    v_sin_f32 v53, v49
    v_cos_f32 v49, v49
    v_fmamk_f32 v50, v8, 0x40000000, v9
    v_sin_f32 v54, v50
    v_cos_f32 v50, v50
    v_fmamk_f32 v51, v8, 0x40400000, v9
    v_sin_f32 v55, v51
    v_cos_f32 v51, v51
    v_mul_f32 v48, 0x36124925, v48
    v_mul_f32 v49, 0x36124925, v49
    v_mul_f32 v50, 0x36124925, v50
    v_mul_f32 v51, 0x36124925, v51
    v_mul_f32 v52, 0x36124925, v52
    v_mul_f32 v53, 0x36124925, v53
    v_mul_f32 v54, 0x36124925, v54
    v_mul_f32 v55, 0x36124925, v55
    ds_write_b128 v7, v[48:51] offset:8192
    ds_write_b128 v7, v[52:55] offset:9216
    s_cmp_ge_u32 s52, 4
    s_cbranch_scc1 T_A
    v_add_f32 v5, 0x3c800000, v5
    v_mul_f32 v6, v3, v5
    v_fmamk_f32 v24, v5, 0x00000000, v6
    v_sin_f32 v28, v24
    v_cos_f32 v24, v24
    v_fmamk_f32 v25, v5, 0x3f800000, v6
    v_sin_f32 v29, v25
    v_cos_f32 v25, v25
    v_fmamk_f32 v26, v5, 0x40000000, v6
    v_sin_f32 v30, v26
    v_cos_f32 v26, v26
    v_fmamk_f32 v27, v5, 0x40400000, v6
    v_sin_f32 v31, v27
    v_cos_f32 v27, v27
    v_cvt_pk_bf16_f32 v16, v24, v28
    v_cvt_pk_bf16_f32 v20, -v28, v24
    v_cvt_pk_bf16_f32 v17, v25, v29
    v_cvt_pk_bf16_f32 v21, -v29, v25
    v_cvt_pk_bf16_f32 v18, v26, v30
    v_cvt_pk_bf16_f32 v22, -v30, v26
    v_cvt_pk_bf16_f32 v19, v27, v31
    v_cvt_pk_bf16_f32 v23, -v31, v27
    ds_write_b128 v7, v[16:19] offset:0
    ds_write_b128 v7, v[20:23] offset:1024
T_A:
    s_lshl_b32 s65, s2, 16
    s_add_u32 s65, s65, s64
    s_add_u32 s73, s65, 4096
    v_bfe_u32 v5, v1, 4, 4
    v_mul_u32_u24 v6, 450, v5
    v_lshrrev_b32 v7, 4, v0
    v_lshl_add_u32 v6, v7, 1, v6
    v_lshlrev_b32 v7, 13, v7
    v_lshl_add_u32 v7, v5, 4, v7
    s_lshl_b32 s66, s2, 8
    s_waitcnt lgkmcnt(0)
    s_or_b32 s59, s59, 0x40004000
    s_add_u32 s59, s59, 1
    s_and_b32 s59, s59, 0xbfffbfff
    v_mov_b32 v14, s59
    s_mov_b32 s63, 0
    s_waitcnt vmcnt(0)
    s_barrier
    ds_read_u16 v16, v6 offset:0
    ds_read_u16 v20, v6 offset:32768
    ds_read_u16 v17, v6 offset:8192
    ds_read_u16 v21, v6 offset:40960
    ds_read_u16 v18, v6 offset:16384
    ds_read_u16 v22, v6 offset:49152
    ds_read_u16 v19, v6 offset:24576
    ds_read_u16 v23, v6 offset:57344
    ds_read_u16 v24, v6 offset:64
    ds_read_u16 v28, v6 offset:32832
    ds_read_u16 v25, v6 offset:8256
    ds_read_u16 v29, v6 offset:41024
    ds_read_u16 v26, v6 offset:16448
    ds_read_u16 v30, v6 offset:49216
    ds_read_u16 v27, v6 offset:24640
    ds_read_u16 v31, v6 offset:57408
    s_waitcnt lgkmcnt(14)
    v_lshl_or_b32 v16, v20, 16, v16
    s_waitcnt lgkmcnt(12)
    v_lshl_or_b32 v17, v21, 16, v17
    s_waitcnt lgkmcnt(10)
    v_lshl_or_b32 v18, v22, 16, v18
    s_waitcnt lgkmcnt(8)
    v_lshl_or_b32 v19, v23, 16, v19
    s_add_u32 s67, s66, 0
    buffer_store_dwordx4 v[16:19], v7, s[28:31], s67 offen sc1
    ds_read_u16 v32, v6 offset:128
    ds_read_u16 v36, v6 offset:32896
    ds_read_u16 v33, v6 offset:8320
    ds_read_u16 v37, v6 offset:41088
    ds_read_u16 v34, v6 offset:16512
    ds_read_u16 v38, v6 offset:49280
    ds_read_u16 v35, v6 offset:24704
    ds_read_u16 v39, v6 offset:57472
    s_waitcnt lgkmcnt(14)
    v_lshl_or_b32 v24, v28, 16, v24
    s_waitcnt lgkmcnt(12)
    v_lshl_or_b32 v25, v29, 16, v25
    s_waitcnt lgkmcnt(10)
    v_lshl_or_b32 v26, v30, 16, v26
    s_waitcnt lgkmcnt(8)
    v_lshl_or_b32 v27, v31, 16, v27
    s_add_u32 s67, s66, 262144
    buffer_store_dwordx4 v[24:27], v7, s[28:31], s67 offen sc1
    ds_read_u16 v40, v6 offset:192
    ds_read_u16 v44, v6 offset:32960
    ds_read_u16 v41, v6 offset:8384
    ds_read_u16 v45, v6 offset:41152
    ds_read_u16 v42, v6 offset:16576
    ds_read_u16 v46, v6 offset:49344
    ds_read_u16 v43, v6 offset:24768
    ds_read_u16 v47, v6 offset:57536
    s_waitcnt lgkmcnt(14)
    v_lshl_or_b32 v32, v36, 16, v32
    s_waitcnt lgkmcnt(12)
    v_lshl_or_b32 v33, v37, 16, v33
    s_waitcnt lgkmcnt(10)
    v_lshl_or_b32 v34, v38, 16, v34
    s_waitcnt lgkmcnt(8)
    v_lshl_or_b32 v35, v39, 16, v35
    s_add_u32 s67, s66, 524288
    buffer_store_dwordx4 v[32:35], v7, s[28:31], s67 offen sc1
    ds_read_u16 v48, v6 offset:256
    ds_read_u16 v52, v6 offset:33024
    ds_read_u16 v49, v6 offset:8448
    ds_read_u16 v53, v6 offset:41216
    ds_read_u16 v50, v6 offset:16640
    ds_read_u16 v54, v6 offset:49408
    ds_read_u16 v51, v6 offset:24832
    ds_read_u16 v55, v6 offset:57600
    s_waitcnt lgkmcnt(14)
    v_lshl_or_b32 v40, v44, 16, v40
    s_waitcnt lgkmcnt(12)
    v_lshl_or_b32 v41, v45, 16, v41
    s_waitcnt lgkmcnt(10)
    v_lshl_or_b32 v42, v46, 16, v42
    s_waitcnt lgkmcnt(8)
    v_lshl_or_b32 v43, v47, 16, v43
    s_add_u32 s67, s66, 786432
    buffer_store_dwordx4 v[40:43], v7, s[28:31], s67 offen sc1
    ds_read_u16 v56, v6 offset:320
    ds_read_u16 v60, v6 offset:33088
    ds_read_u16 v57, v6 offset:8512
    ds_read_u16 v61, v6 offset:41280
    ds_read_u16 v58, v6 offset:16704
    ds_read_u16 v62, v6 offset:49472
    ds_read_u16 v59, v6 offset:24896
    ds_read_u16 v63, v6 offset:57664
    s_waitcnt lgkmcnt(14)
    v_lshl_or_b32 v48, v52, 16, v48
    s_waitcnt lgkmcnt(12)
    v_lshl_or_b32 v49, v53, 16, v49
    s_waitcnt lgkmcnt(10)
    v_lshl_or_b32 v50, v54, 16, v50
    s_waitcnt lgkmcnt(8)
    v_lshl_or_b32 v51, v55, 16, v51
    s_add_u32 s67, s66, 1048576
    buffer_store_dwordx4 v[48:51], v7, s[28:31], s67 offen sc1
    ds_read_u16 v64, v6 offset:384
    ds_read_u16 v68, v6 offset:33152
    ds_read_u16 v65, v6 offset:8576
    ds_read_u16 v69, v6 offset:41344
    ds_read_u16 v66, v6 offset:16768
    ds_read_u16 v70, v6 offset:49536
    ds_read_u16 v67, v6 offset:24960
    ds_read_u16 v71, v6 offset:57728
    s_waitcnt lgkmcnt(14)
    v_lshl_or_b32 v56, v60, 16, v56
    s_waitcnt lgkmcnt(12)
    v_lshl_or_b32 v57, v61, 16, v57
    s_waitcnt lgkmcnt(10)
    v_lshl_or_b32 v58, v62, 16, v58
    s_waitcnt lgkmcnt(8)
    v_lshl_or_b32 v59, v63, 16, v59
    s_add_u32 s67, s66, 1310720
    buffer_store_dwordx4 v[56:59], v7, s[28:31], s67 offen sc1
    ds_read_u16 v72, v6 offset:448
    ds_read_u16 v76, v6 offset:33216
    ds_read_u16 v73, v6 offset:8640
    ds_read_u16 v77, v6 offset:41408
    ds_read_u16 v74, v6 offset:16832
    ds_read_u16 v78, v6 offset:49600
    ds_read_u16 v75, v6 offset:25024
    ds_read_u16 v79, v6 offset:57792
    s_waitcnt lgkmcnt(14)
    v_lshl_or_b32 v64, v68, 16, v64
    s_waitcnt lgkmcnt(12)
    v_lshl_or_b32 v65, v69, 16, v65
    s_waitcnt lgkmcnt(10)
    v_lshl_or_b32 v66, v70, 16, v66
    s_waitcnt lgkmcnt(8)
    v_lshl_or_b32 v67, v71, 16, v67
    s_add_u32 s67, s66, 1572864
    buffer_store_dwordx4 v[64:67], v7, s[28:31], s67 offen sc1
    s_waitcnt lgkmcnt(6)
    v_lshl_or_b32 v72, v76, 16, v72
    s_waitcnt lgkmcnt(4)
    v_lshl_or_b32 v73, v77, 16, v73
    s_waitcnt lgkmcnt(2)
    v_lshl_or_b32 v74, v78, 16, v74
    s_waitcnt lgkmcnt(0)
    v_lshl_or_b32 v75, v79, 16, v75
    s_add_u32 s67, s66, 1835008
    buffer_store_dwordx4 v[72:75], v7, s[28:31], s67 offen sc1
    s_barrier
    v_add_u32 v11, 65536, v1
    ds_read_b128 v[80:83], v11 offset:24576
    ds_read_b128 v[112:115], v11 offset:32768
    ds_read_b128 v[84:87], v11 offset:25600
    ds_read_b128 v[116:119], v11 offset:33792
    ds_read_b128 v[88:91], v11 offset:26624
    ds_read_b128 v[120:123], v11 offset:34816
    ds_read_b128 v[92:95], v11 offset:27648
    ds_read_b128 v[124:127], v11 offset:35840
    ds_read_b128 v[96:99], v11 offset:28672
    ds_read_b128 v[128:131], v11 offset:36864
    ds_read_b128 v[100:103], v11 offset:29696
    ds_read_b128 v[132:135], v11 offset:37888
    ds_read_b128 v[104:107], v11 offset:30720
    ds_read_b128 v[136:139], v11 offset:38912
    ds_read_b128 v[108:111], v11 offset:31744
    ds_read_b128 v[140:143], v11 offset:39936
    s_lshl_b32 s62, s52, 5
    s_add_u32 s62, s62, s2
    s_lshl_b32 s62, s62, 7
    s_add_u32 s62, s62, 4325376
    s_cmp_lt_u32 s2, 29
    s_cbranch_scc1 T_M
    s_waitcnt vmcnt(0)
    s_mov_b64 exec, 255
    buffer_store_dwordx4 v[12:15], v1, s[40:43], s62 offen sc1
    s_mov_b64 exec, -1
    s_branch T_FIN
T_M:
    s_lshl_b32 s55, s2, 3
    s_add_u32 s55, s55, s52
    v_bfe_u32 v10, v1, 6, 3
    v_lshlrev_b32 v2, 10, v10
    v_bfe_u32 v10, v1, 4, 2
    v_lshl_add_u32 v2, v10, 7, v2
    v_lshrrev_b32 v10, 5, v1
    v_and_b32 v10, 16, v10
    v_and_b32 v12, 0x70, v1
    v_xor_b32 v10, v10, v12
    s_add_u32 s66, s64, 98304
    v_add3_u32 v2, v2, v10, s66
    v_xor_b32 v3, 32, v2
    v_xor_b32 v4, 64, v2
    v_xor_b32 v5, 96, v2
    v_bfe_u32 v6, v1, 4, 5
    v_lshlrev_b32 v6, 2, v6
    v_lshrrev_b32 v10, 9, v1
    v_lshl_add_u32 v6, v10, 15, v6
    s_and_b32 s66, s52, 1
    s_lshl_b32 s66, s66, 6
    v_xor_b32 v6, s66, v6
    s_lshl_b32 s66, s52, 10
    s_add_u32 s66, s66, 98304
    v_add_u32 v6, s66, v6
    v_xor_b32 v7, 144, v6
    v_xor_b32 v8, 288, v6
    v_xor_b32 v9, 432, v6
    s_lshr_b32 s66, s55, 2
    s_and_b32 s67, s66, 7
    s_lshl_b32 s67, s67, 12
    s_add_u32 s72, s67, 4325376
    s_lshr_b32 s66, s2, 1
    s_cmp_eq_u32 s2, 28
    s_cselect_b32 s66, 0, s66
    s_lshl_b32 s66, s66, 13
    s_lshl_b32 s67, s52, 10
    s_add_u32 s66, s66, s67
    s_add_u32 s66, s66, 4194304
    v_bfe_u32 v10, v1, 4, 3
    v_lshlrev_b32 v10, 7, v10
    v_bfe_u32 v13, v1, 4, 5
    v_lshlrev_b32 v13, 7, v13
    v_bfe_u32 v0, v1, 7, 1
    v_bfe_u32 v15, v1, 8, 1
    v_lshl_add_u32 v0, v0, 1, v15
    v_bfe_u32 v15, v1, 4, 1
    v_lshl_add_u32 v0, v0, 1, v15
    v_xor_b32 v15, s52, v0
    v_lshlrev_b32 v15, 5, v15
    v_lshl_add_u32 v15, v0, 8, v15
    v_bfe_u32 v0, v1, 5, 2
    v_lshl_add_u32 v15, v0, 3, v15
    v_lshrrev_b32 v0, 9, v1
    v_lshl_add_u32 v15, v0, 13, v15
    v_lshrrev_b32 v240, 3, v1
    v_and_b32 v240, 0x60, v240
    v_xor_b32 v240, v240, v1
    v_add_u32 v240, s64, v240
    v_xor_b32 v241, 128, v240
    v_and_b32 v0, 0xe0, v1
    s_cmp_eq_u32 s2, 28
    s_cselect_b32 s67, 0, 0xe0
    v_cmp_ge_u32 s[74:75], s67, v0
    s_lshl_b32 s68, s55, 13
    s_add_u32 s69, s68, 4096
    s_cmp_gt_u32 s55, 224
    s_cselect_b32 s56, 1, 0
    s_waitcnt vmcnt(0)
    s_mov_b64 exec, 255
    buffer_store_dwordx4 v[12:15], v1, s[40:43], s62 offen sc1
    s_mov_b64 exec, -1
    s_nop 0
    buffer_load_dword v12, v10, s[40:43], s66 offen offset:8 sc1
    s_waitcnt vmcnt(0)
    v_cmp_ne_u32 vcc, s59, v12
    s_cbranch_vccnz spin_33
ok_32:
    s_waitcnt vmcnt(0) lgkmcnt(0)
T_P:
    buffer_load_dword v12, v13, s[40:43], s72 offen offset:8 sc1
    buffer_load_dwordx4 v[144:147], v1, s[40:43], s65 offen offset:0 sc1
    buffer_load_dwordx4 v[148:151], v1, s[40:43], s65 offen offset:1024 sc1
    buffer_load_dwordx4 v[152:155], v1, s[40:43], s65 offen offset:2048 sc1
    buffer_load_dwordx4 v[156:159], v1, s[40:43], s65 offen offset:3072 sc1
    buffer_load_dwordx4 v[160:163], v1, s[40:43], s73 offen offset:0 sc1
    buffer_load_dwordx4 v[164:167], v1, s[40:43], s73 offen offset:1024 sc1
    buffer_load_dwordx4 v[168:171], v1, s[40:43], s73 offen offset:2048 sc1
    buffer_load_dwordx4 v[172:175], v1, s[40:43], s73 offen offset:3072 sc1
    s_waitcnt vmcnt(8)
    v_cmp_ne_u32 vcc, s59, v12
    s_cmp_lg_u32 s56, 0
    s_cbranch_scc1 T_P1
    s_cbranch_vccnz T_P1
    s_mov_b32 s56, 1
    buffer_load_dwordx4 v[48:51], v1, s[28:31], s68 offen offset:0 sc1
    buffer_load_dwordx4 v[52:55], v1, s[28:31], s68 offen offset:1024 sc1
    buffer_load_dwordx4 v[56:59], v1, s[28:31], s68 offen offset:2048 sc1
    buffer_load_dwordx4 v[60:63], v1, s[28:31], s68 offen offset:3072 sc1
    buffer_load_dwordx4 v[64:67], v1, s[28:31], s69 offen offset:0 sc1
    buffer_load_dwordx4 v[68:71], v1, s[28:31], s69 offen offset:1024 sc1
    buffer_load_dwordx4 v[72:75], v1, s[28:31], s69 offen offset:2048 sc1
    buffer_load_dwordx4 v[76:79], v1, s[28:31], s69 offen offset:3072 sc1
    s_waitcnt vmcnt(8)
    s_branch T_P2
T_P1:
    s_waitcnt vmcnt(0)
T_P2:
    v_max3_u32 v0, v147, v151, v155
    v_max3_u32 v0, v0, v159, v163
    v_max3_u32 v0, v0, v167, v171
    v_max_u32 v0, v0, v175
    v_cmp_eq_u32 vcc, -1, v0
    s_add_u32 s63, s63, 1
    s_cmp_ge_u32 s63, 0x4000
    s_cbranch_scc1 T_P3
    s_and_b64 vcc, vcc, s[74:75]
    s_cbranch_scc1 T_P
T_P3:
    ds_write_b128 v240, v[144:147] offset:0
    ds_write_b128 v241, v[148:151] offset:1024
    ds_write_b128 v240, v[152:155] offset:2048
    ds_write_b128 v241, v[156:159] offset:3072
    ds_write_b128 v240, v[160:163] offset:4096
    ds_write_b128 v241, v[164:167] offset:5120
    ds_write_b128 v240, v[168:171] offset:6144
    ds_write_b128 v241, v[172:175] offset:7168
    s_waitcnt lgkmcnt(0)
    s_barrier
    s_cmp_le_u32 s55, 224
    s_cbranch_scc1 T_I
    v_mov_b32 v16, 0
    v_mov_b32 v17, 0
    v_mov_b32 v18, 0
    v_mov_b32 v19, 0
    ds_write_b128 v2, v[16:19] offset:0
    ds_write_b128 v3, v[16:19] offset:0
    ds_write_b128 v4, v[16:19] offset:0
    ds_write_b128 v5, v[16:19] offset:0
    ds_write_b128 v2, v[16:19] offset:512
    ds_write_b128 v3, v[16:19] offset:512
    ds_write_b128 v4, v[16:19] offset:512
    ds_write_b128 v5, v[16:19] offset:512
    s_branch T_X
T_I:
    ds_read_b64_tr_b16 v[16:17], v15 offset:0
    ds_read_b64_tr_b16 v[18:19], v15 offset:2048
    ds_read_b64_tr_b16 v[20:21], v15 offset:16384
    ds_read_b64_tr_b16 v[22:23], v15 offset:18432
    ds_read_b64_tr_b16 v[24:25], v15 offset:32768
    ds_read_b64_tr_b16 v[26:27], v15 offset:34816
    ds_read_b64_tr_b16 v[28:29], v15 offset:49152
    ds_read_b64_tr_b16 v[30:31], v15 offset:51200
    ds_read_b64_tr_b16 v[32:33], v15 offset:4096
    ds_read_b64_tr_b16 v[34:35], v15 offset:6144
    ds_read_b64_tr_b16 v[36:37], v15 offset:20480
    ds_read_b64_tr_b16 v[38:39], v15 offset:22528
    ds_read_b64_tr_b16 v[40:41], v15 offset:36864
    ds_read_b64_tr_b16 v[42:43], v15 offset:38912
    s_waitcnt lgkmcnt(12)
    v_mfma_f32_32x32x16_bf16 v[144:159], v[80:83], v[16:19], 0
    v_mfma_f32_32x32x16_bf16 v[160:175], v[84:87], v[16:19], 0
    ds_read_b64_tr_b16 v[44:45], v15 offset:53248
    ds_read_b64_tr_b16 v[46:47], v15 offset:55296
    s_waitcnt lgkmcnt(12)
    v_mfma_f32_32x32x16_bf16 v[144:159], v[88:91], v[20:23], v[144:159]
    v_mfma_f32_32x32x16_bf16 v[160:175], v[92:95], v[20:23], v[160:175]
    s_waitcnt lgkmcnt(10)
    v_mfma_f32_32x32x16_bf16 v[144:159], v[96:99], v[24:27], v[144:159]
    v_mfma_f32_32x32x16_bf16 v[160:175], v[100:103], v[24:27], v[160:175]
    s_waitcnt lgkmcnt(8)
    v_mfma_f32_32x32x16_bf16 v[144:159], v[104:107], v[28:31], v[144:159]
    v_mfma_f32_32x32x16_bf16 v[160:175], v[108:111], v[28:31], v[160:175]
    s_cmp_lg_u32 s56, 0
    s_cbranch_scc1 T_W
    buffer_load_dword v12, v13, s[40:43], s72 offen offset:8 sc1
    s_waitcnt vmcnt(0)
    v_cmp_ne_u32 vcc, s59, v12
    s_cbranch_vccnz spin_35
ok_34:
    buffer_load_dwordx4 v[48:51], v1, s[28:31], s68 offen offset:0 sc1
    buffer_load_dwordx4 v[52:55], v1, s[28:31], s68 offen offset:1024 sc1
    buffer_load_dwordx4 v[56:59], v1, s[28:31], s68 offen offset:2048 sc1
    buffer_load_dwordx4 v[60:63], v1, s[28:31], s68 offen offset:3072 sc1
    buffer_load_dwordx4 v[64:67], v1, s[28:31], s69 offen offset:0 sc1
    buffer_load_dwordx4 v[68:71], v1, s[28:31], s69 offen offset:1024 sc1
    buffer_load_dwordx4 v[72:75], v1, s[28:31], s69 offen offset:2048 sc1
    buffer_load_dwordx4 v[76:79], v1, s[28:31], s69 offen offset:3072 sc1
T_W:
    s_waitcnt lgkmcnt(6)
    v_mfma_f32_32x32x16_bf16 v[176:191], v[112:115], v[32:35], v[144:159]
    v_mfma_f32_32x32x16_bf16 v[192:207], v[116:119], v[32:35], v[160:175]
    s_waitcnt lgkmcnt(4)
    v_mfma_f32_32x32x16_bf16 v[176:191], v[120:123], v[36:39], v[176:191]
    v_mfma_f32_32x32x16_bf16 v[192:207], v[124:127], v[36:39], v[192:207]
    s_waitcnt lgkmcnt(2)
    v_mfma_f32_32x32x16_bf16 v[176:191], v[128:131], v[40:43], v[176:191]
    v_mfma_f32_32x32x16_bf16 v[192:207], v[132:135], v[40:43], v[192:207]
    s_waitcnt lgkmcnt(0)
    v_mfma_f32_32x32x16_bf16 v[176:191], v[136:139], v[44:47], v[176:191]
    v_mfma_f32_32x32x16_bf16 v[192:207], v[140:143], v[44:47], v[192:207]
    ds_read_b128 v[112:115], v11 offset:0
    ds_read_b128 v[116:119], v11 offset:1024
    ds_read_b128 v[120:123], v11 offset:2048
    ds_read_b128 v[124:127], v11 offset:3072
    ds_read_b128 v[128:131], v11 offset:4096
    ds_read_b128 v[132:135], v11 offset:5120
    ds_read_b128 v[136:139], v11 offset:6144
    ds_read_b128 v[140:143], v11 offset:7168
    s_waitcnt vmcnt(0)
    v_lshlrev_b32 v208, 16, v48
    v_and_b32 v48, 0xffff0000, v48
    v_lshlrev_b32 v209, 16, v49
    v_and_b32 v49, 0xffff0000, v49
    v_lshlrev_b32 v210, 16, v50
    v_and_b32 v50, 0xffff0000, v50
    v_lshlrev_b32 v211, 16, v51
    v_and_b32 v51, 0xffff0000, v51
    s_waitcnt vmcnt(0)
    v_lshlrev_b32 v212, 16, v52
    v_and_b32 v52, 0xffff0000, v52
    v_lshlrev_b32 v213, 16, v53
    v_and_b32 v53, 0xffff0000, v53
    v_lshlrev_b32 v214, 16, v54
    v_and_b32 v54, 0xffff0000, v54
    v_lshlrev_b32 v215, 16, v55
    v_and_b32 v55, 0xffff0000, v55
    s_waitcnt vmcnt(0)
    v_lshlrev_b32 v216, 16, v56
    v_and_b32 v56, 0xffff0000, v56
    v_lshlrev_b32 v217, 16, v57
    v_and_b32 v57, 0xffff0000, v57
    v_lshlrev_b32 v218, 16, v58
    v_and_b32 v58, 0xffff0000, v58
    v_lshlrev_b32 v219, 16, v59
    v_and_b32 v59, 0xffff0000, v59
    s_waitcnt vmcnt(0)
    v_lshlrev_b32 v220, 16, v60
    v_and_b32 v60, 0xffff0000, v60
    v_lshlrev_b32 v221, 16, v61
    v_and_b32 v61, 0xffff0000, v61
    v_lshlrev_b32 v222, 16, v62
    v_and_b32 v62, 0xffff0000, v62
    v_lshlrev_b32 v223, 16, v63
    v_and_b32 v63, 0xffff0000, v63
    s_waitcnt vmcnt(0)
    v_lshlrev_b32 v224, 16, v64
    v_and_b32 v64, 0xffff0000, v64
    v_lshlrev_b32 v225, 16, v65
    v_and_b32 v65, 0xffff0000, v65
    v_lshlrev_b32 v226, 16, v66
    v_and_b32 v66, 0xffff0000, v66
    v_lshlrev_b32 v227, 16, v67
    v_and_b32 v67, 0xffff0000, v67
    s_waitcnt vmcnt(0)
    v_lshlrev_b32 v228, 16, v68
    v_and_b32 v68, 0xffff0000, v68
    v_lshlrev_b32 v229, 16, v69
    v_and_b32 v69, 0xffff0000, v69
    v_lshlrev_b32 v230, 16, v70
    v_and_b32 v70, 0xffff0000, v70
    v_lshlrev_b32 v231, 16, v71
    v_and_b32 v71, 0xffff0000, v71
    s_waitcnt vmcnt(0)
    v_lshlrev_b32 v232, 16, v72
    v_and_b32 v72, 0xffff0000, v72
    v_lshlrev_b32 v233, 16, v73
    v_and_b32 v73, 0xffff0000, v73
    v_lshlrev_b32 v234, 16, v74
    v_and_b32 v74, 0xffff0000, v74
    v_lshlrev_b32 v235, 16, v75
    v_and_b32 v75, 0xffff0000, v75
    s_waitcnt vmcnt(0)
    v_lshlrev_b32 v236, 16, v76
    v_and_b32 v76, 0xffff0000, v76
    v_lshlrev_b32 v237, 16, v77
    v_and_b32 v77, 0xffff0000, v77
    v_lshlrev_b32 v238, 16, v78
    v_and_b32 v78, 0xffff0000, v78
    v_lshlrev_b32 v239, 16, v79
    v_and_b32 v79, 0xffff0000, v79
    v_fma_f32 v144, 2.0, v144, -v176
    v_fma_f32 v145, 2.0, v145, -v177
    v_fma_f32 v146, 2.0, v146, -v178
    v_fma_f32 v147, 2.0, v147, -v179
    v_fma_f32 v160, 2.0, v160, -v192
    v_fma_f32 v161, 2.0, v161, -v193
    v_fma_f32 v162, 2.0, v162, -v194
    v_fma_f32 v163, 2.0, v163, -v195
    v_mul_f32 v240, v176, v208
    v_mul_f32 v241, v177, v209
    v_mul_f32 v242, v178, v210
    v_mul_f32 v243, v179, v211
    v_mul_f32 v248, v176, v48
    v_mul_f32 v249, v177, v49
    v_mul_f32 v250, v178, v50
    v_mul_f32 v251, v179, v51
    v_fma_f32 v240, -v192, v48, v240
    v_fma_f32 v241, -v193, v49, v241
    v_fma_f32 v242, -v194, v50, v242
    v_fma_f32 v243, -v195, v51, v243
    v_fmac_f32 v248, v192, v208
    v_fmac_f32 v249, v193, v209
    v_fmac_f32 v250, v194, v210
    v_fmac_f32 v251, v195, v211
    v_fma_f32 v176, v144, v224, v240
    v_fma_f32 v177, v145, v225, v241
    v_fma_f32 v178, v146, v226, v242
    v_fma_f32 v179, v147, v227, v243
    v_fma_f32 v192, v144, v64, v248
    v_fma_f32 v193, v145, v65, v249
    v_fma_f32 v194, v146, v66, v250
    v_fma_f32 v195, v147, v67, v251
    v_fma_f32 v176, -v160, v64, v176
    v_fma_f32 v177, -v161, v65, v177
    v_fma_f32 v178, -v162, v66, v178
    v_fma_f32 v179, -v163, v67, v179
    v_fmac_f32 v192, v160, v224
    v_fmac_f32 v193, v161, v225
    v_fmac_f32 v194, v162, v226
    v_fmac_f32 v195, v163, v227
    v_fma_f32 v240, 2.0, v240, -v176
    v_fma_f32 v241, 2.0, v241, -v177
    v_fma_f32 v242, 2.0, v242, -v178
    v_fma_f32 v243, 2.0, v243, -v179
    v_fma_f32 v248, 2.0, v248, -v192
    v_fma_f32 v249, 2.0, v249, -v193
    v_fma_f32 v250, 2.0, v250, -v194
    v_fma_f32 v251, 2.0, v251, -v195
    v_cvt_pk_bf16_f32 v16, v176, -v192
    v_cvt_pk_bf16_f32 v17, v177, -v193
    v_cvt_pk_bf16_f32 v18, v178, -v194
    v_cvt_pk_bf16_f32 v19, v179, -v195
    v_cvt_pk_bf16_f32 v32, v240, -v248
    v_cvt_pk_bf16_f32 v33, v241, -v249
    v_cvt_pk_bf16_f32 v34, v242, -v250
    v_cvt_pk_bf16_f32 v35, v243, -v251
    v_fma_f32 v148, 2.0, v148, -v180
    v_fma_f32 v149, 2.0, v149, -v181
    v_fma_f32 v150, 2.0, v150, -v182
    v_fma_f32 v151, 2.0, v151, -v183
    v_fma_f32 v164, 2.0, v164, -v196
    v_fma_f32 v165, 2.0, v165, -v197
    v_fma_f32 v166, 2.0, v166, -v198
    v_fma_f32 v167, 2.0, v167, -v199
    v_mul_f32 v240, v180, v212
    v_mul_f32 v241, v181, v213
    v_mul_f32 v242, v182, v214
    v_mul_f32 v243, v183, v215
    v_mul_f32 v248, v180, v52
    v_mul_f32 v249, v181, v53
    v_mul_f32 v250, v182, v54
    v_mul_f32 v251, v183, v55
    v_fma_f32 v240, -v196, v52, v240
    v_fma_f32 v241, -v197, v53, v241
    v_fma_f32 v242, -v198, v54, v242
    v_fma_f32 v243, -v199, v55, v243
    v_fmac_f32 v248, v196, v212
    v_fmac_f32 v249, v197, v213
    v_fmac_f32 v250, v198, v214
    v_fmac_f32 v251, v199, v215
    v_fma_f32 v180, v148, v228, v240
    v_fma_f32 v181, v149, v229, v241
    v_fma_f32 v182, v150, v230, v242
    v_fma_f32 v183, v151, v231, v243
    v_fma_f32 v196, v148, v68, v248
    v_fma_f32 v197, v149, v69, v249
    v_fma_f32 v198, v150, v70, v250
    v_fma_f32 v199, v151, v71, v251
    v_fma_f32 v180, -v164, v68, v180
    v_fma_f32 v181, -v165, v69, v181
    v_fma_f32 v182, -v166, v70, v182
    v_fma_f32 v183, -v167, v71, v183
    v_fmac_f32 v196, v164, v228
    v_fmac_f32 v197, v165, v229
    v_fmac_f32 v198, v166, v230
    v_fmac_f32 v199, v167, v231
    v_fma_f32 v240, 2.0, v240, -v180
    v_fma_f32 v241, 2.0, v241, -v181
    v_fma_f32 v242, 2.0, v242, -v182
    v_fma_f32 v243, 2.0, v243, -v183
    v_fma_f32 v248, 2.0, v248, -v196
    v_fma_f32 v249, 2.0, v249, -v197
    v_fma_f32 v250, 2.0, v250, -v198
    v_fma_f32 v251, 2.0, v251, -v199
    v_cvt_pk_bf16_f32 v20, v180, -v196
    v_cvt_pk_bf16_f32 v21, v181, -v197
    v_cvt_pk_bf16_f32 v22, v182, -v198
    v_cvt_pk_bf16_f32 v23, v183, -v199
    v_cvt_pk_bf16_f32 v36, v240, -v248
    v_cvt_pk_bf16_f32 v37, v241, -v249
    v_cvt_pk_bf16_f32 v38, v242, -v250
    v_cvt_pk_bf16_f32 v39, v243, -v251
    v_fma_f32 v152, 2.0, v152, -v184
    v_fma_f32 v153, 2.0, v153, -v185
    v_fma_f32 v154, 2.0, v154, -v186
    v_fma_f32 v155, 2.0, v155, -v187
    v_fma_f32 v168, 2.0, v168, -v200
    v_fma_f32 v169, 2.0, v169, -v201
    v_fma_f32 v170, 2.0, v170, -v202
    v_fma_f32 v171, 2.0, v171, -v203
    v_mul_f32 v240, v184, v216
    v_mul_f32 v241, v185, v217
    v_mul_f32 v242, v186, v218
    v_mul_f32 v243, v187, v219
    v_mul_f32 v248, v184, v56
    v_mul_f32 v249, v185, v57
    v_mul_f32 v250, v186, v58
    v_mul_f32 v251, v187, v59
    v_fma_f32 v240, -v200, v56, v240
    v_fma_f32 v241, -v201, v57, v241
    v_fma_f32 v242, -v202, v58, v242
    v_fma_f32 v243, -v203, v59, v243
    v_fmac_f32 v248, v200, v216
    v_fmac_f32 v249, v201, v217
    v_fmac_f32 v250, v202, v218
    v_fmac_f32 v251, v203, v219
    v_fma_f32 v184, v152, v232, v240
    v_fma_f32 v185, v153, v233, v241
    v_fma_f32 v186, v154, v234, v242
    v_fma_f32 v187, v155, v235, v243
    v_fma_f32 v200, v152, v72, v248
    v_fma_f32 v201, v153, v73, v249
    v_fma_f32 v202, v154, v74, v250
    v_fma_f32 v203, v155, v75, v251
    v_fma_f32 v184, -v168, v72, v184
    v_fma_f32 v185, -v169, v73, v185
    v_fma_f32 v186, -v170, v74, v186
    v_fma_f32 v187, -v171, v75, v187
    v_fmac_f32 v200, v168, v232
    v_fmac_f32 v201, v169, v233
    v_fmac_f32 v202, v170, v234
    v_fmac_f32 v203, v171, v235
    v_fma_f32 v240, 2.0, v240, -v184
    v_fma_f32 v241, 2.0, v241, -v185
    v_fma_f32 v242, 2.0, v242, -v186
    v_fma_f32 v243, 2.0, v243, -v187
    v_fma_f32 v248, 2.0, v248, -v200
    v_fma_f32 v249, 2.0, v249, -v201
    v_fma_f32 v250, 2.0, v250, -v202
    v_fma_f32 v251, 2.0, v251, -v203
    v_cvt_pk_bf16_f32 v24, v184, -v200
    v_cvt_pk_bf16_f32 v25, v185, -v201
    v_cvt_pk_bf16_f32 v26, v186, -v202
    v_cvt_pk_bf16_f32 v27, v187, -v203
    v_cvt_pk_bf16_f32 v40, v240, -v248
    v_cvt_pk_bf16_f32 v41, v241, -v249
    v_cvt_pk_bf16_f32 v42, v242, -v250
    v_cvt_pk_bf16_f32 v43, v243, -v251
    v_fma_f32 v156, 2.0, v156, -v188
    v_fma_f32 v157, 2.0, v157, -v189
    v_fma_f32 v158, 2.0, v158, -v190
    v_fma_f32 v159, 2.0, v159, -v191
    v_fma_f32 v172, 2.0, v172, -v204
    v_fma_f32 v173, 2.0, v173, -v205
    v_fma_f32 v174, 2.0, v174, -v206
    v_fma_f32 v175, 2.0, v175, -v207
    v_mul_f32 v240, v188, v220
    v_mul_f32 v241, v189, v221
    v_mul_f32 v242, v190, v222
    v_mul_f32 v243, v191, v223
    v_mul_f32 v248, v188, v60
    v_mul_f32 v249, v189, v61
    v_mul_f32 v250, v190, v62
    v_mul_f32 v251, v191, v63
    v_fma_f32 v240, -v204, v60, v240
    v_fma_f32 v241, -v205, v61, v241
    v_fma_f32 v242, -v206, v62, v242
    v_fma_f32 v243, -v207, v63, v243
    v_fmac_f32 v248, v204, v220
    v_fmac_f32 v249, v205, v221
    v_fmac_f32 v250, v206, v222
    v_fmac_f32 v251, v207, v223
    v_fma_f32 v188, v156, v236, v240
    v_fma_f32 v189, v157, v237, v241
    v_fma_f32 v190, v158, v238, v242
    v_fma_f32 v191, v159, v239, v243
    v_fma_f32 v204, v156, v76, v248
    v_fma_f32 v205, v157, v77, v249
    v_fma_f32 v206, v158, v78, v250
    v_fma_f32 v207, v159, v79, v251
    v_fma_f32 v188, -v172, v76, v188
    v_fma_f32 v189, -v173, v77, v189
    v_fma_f32 v190, -v174, v78, v190
    v_fma_f32 v191, -v175, v79, v191
    v_fmac_f32 v204, v172, v236
    v_fmac_f32 v205, v173, v237
    v_fmac_f32 v206, v174, v238
    v_fmac_f32 v207, v175, v239
    v_fma_f32 v240, 2.0, v240, -v188
    v_fma_f32 v241, 2.0, v241, -v189
    v_fma_f32 v242, 2.0, v242, -v190
    v_fma_f32 v243, 2.0, v243, -v191
    v_fma_f32 v248, 2.0, v248, -v204
    v_fma_f32 v249, 2.0, v249, -v205
    v_fma_f32 v250, 2.0, v250, -v206
    v_fma_f32 v251, 2.0, v251, -v207
    v_cvt_pk_bf16_f32 v28, v188, -v204
    v_cvt_pk_bf16_f32 v29, v189, -v205
    v_cvt_pk_bf16_f32 v30, v190, -v206
    v_cvt_pk_bf16_f32 v31, v191, -v207
    v_cvt_pk_bf16_f32 v44, v240, -v248
    v_cvt_pk_bf16_f32 v45, v241, -v249
    v_cvt_pk_bf16_f32 v46, v242, -v250
    v_cvt_pk_bf16_f32 v47, v243, -v251
    ds_read_b128 v[48:51], v11 offset:8192
    ds_read_b128 v[52:55], v11 offset:9216
    ds_read_b128 v[56:59], v11 offset:10240
    ds_read_b128 v[60:63], v11 offset:11264
    ds_read_b128 v[64:67], v11 offset:12288
    ds_read_b128 v[68:71], v11 offset:13312
    ds_read_b128 v[72:75], v11 offset:14336
    ds_read_b128 v[76:79], v11 offset:15360
    ds_read_b128 v[208:211], v11 offset:16384
    ds_read_b128 v[212:215], v11 offset:17408
    ds_read_b128 v[216:219], v11 offset:18432
    ds_read_b128 v[220:223], v11 offset:19456
    ds_read_b128 v[224:227], v11 offset:20480
    ds_read_b128 v[228:231], v11 offset:21504
    ds_read_b128 v[232:235], v11 offset:22528
    ds_read_b128 v[236:239], v11 offset:23552
    v_mfma_f32_32x32x16_bf16 v[144:159], v[16:19], v[80:83], 0
    v_mfma_f32_32x32x16_bf16 v[160:175], v[16:19], v[84:87], 0
    v_mfma_f32_32x32x16_bf16 v[144:159], v[20:23], v[88:91], v[144:159]
    v_mfma_f32_32x32x16_bf16 v[160:175], v[20:23], v[92:95], v[160:175]
    v_mfma_f32_32x32x16_bf16 v[144:159], v[24:27], v[96:99], v[144:159]
    v_mfma_f32_32x32x16_bf16 v[160:175], v[24:27], v[100:103], v[160:175]
    v_mfma_f32_32x32x16_bf16 v[144:159], v[28:31], v[104:107], v[144:159]
    v_mfma_f32_32x32x16_bf16 v[160:175], v[28:31], v[108:111], v[160:175]
    s_waitcnt lgkmcnt(15)
    v_mfma_f32_32x32x16_bf16 v[176:191], v[32:35], v[112:115], 0
    s_waitcnt lgkmcnt(15)
    v_mfma_f32_32x32x16_bf16 v[192:207], v[32:35], v[116:119], 0
    s_waitcnt lgkmcnt(15)
    v_mfma_f32_32x32x16_bf16 v[176:191], v[36:39], v[120:123], v[176:191]
    s_waitcnt lgkmcnt(15)
    v_mfma_f32_32x32x16_bf16 v[192:207], v[36:39], v[124:127], v[192:207]
    s_waitcnt lgkmcnt(15)
    v_mfma_f32_32x32x16_bf16 v[176:191], v[40:43], v[128:131], v[176:191]
    s_waitcnt lgkmcnt(15)
    v_mfma_f32_32x32x16_bf16 v[192:207], v[40:43], v[132:135], v[192:207]
    s_waitcnt lgkmcnt(15)
    v_mfma_f32_32x32x16_bf16 v[176:191], v[44:47], v[136:139], v[176:191]
    s_waitcnt lgkmcnt(15)
    v_mfma_f32_32x32x16_bf16 v[192:207], v[44:47], v[140:143], v[192:207]
    s_waitcnt lgkmcnt(15)
    v_mul_f32 v240, v144, v48
    v_mul_f32 v241, v145, v49
    v_mul_f32 v242, v146, v50
    v_mul_f32 v243, v147, v51
    v_mul_f32 v248, v160, v48
    v_mul_f32 v249, v161, v49
    v_mul_f32 v250, v162, v50
    v_mul_f32 v251, v163, v51
    s_waitcnt lgkmcnt(14)
    v_fmac_f32 v240, v160, v52
    v_fmac_f32 v241, v161, v53
    v_fmac_f32 v242, v162, v54
    v_fmac_f32 v243, v163, v55
    v_fma_f32 v248, -v144, v52, v248
    v_fma_f32 v249, -v145, v53, v249
    v_fma_f32 v250, -v146, v54, v250
    v_fma_f32 v251, -v147, v55, v251
    v_cvt_pk_bf16_f32 v16, v240, v248
    v_cvt_pk_bf16_f32 v17, v241, v249
    v_cvt_pk_bf16_f32 v18, v242, v250
    v_cvt_pk_bf16_f32 v19, v243, v251
    s_waitcnt lgkmcnt(13)
    v_mul_f32 v240, v148, v56
    v_mul_f32 v241, v149, v57
    v_mul_f32 v242, v150, v58
    v_mul_f32 v243, v151, v59
    v_mul_f32 v248, v164, v56
    v_mul_f32 v249, v165, v57
    v_mul_f32 v250, v166, v58
    v_mul_f32 v251, v167, v59
    s_waitcnt lgkmcnt(12)
    v_fmac_f32 v240, v164, v60
    v_fmac_f32 v241, v165, v61
    v_fmac_f32 v242, v166, v62
    v_fmac_f32 v243, v167, v63
    v_fma_f32 v248, -v148, v60, v248
    v_fma_f32 v249, -v149, v61, v249
    v_fma_f32 v250, -v150, v62, v250
    v_fma_f32 v251, -v151, v63, v251
    v_cvt_pk_bf16_f32 v20, v240, v248
    v_cvt_pk_bf16_f32 v21, v241, v249
    v_cvt_pk_bf16_f32 v22, v242, v250
    v_cvt_pk_bf16_f32 v23, v243, v251
    s_waitcnt lgkmcnt(11)
    v_mul_f32 v240, v152, v64
    v_mul_f32 v241, v153, v65
    v_mul_f32 v242, v154, v66
    v_mul_f32 v243, v155, v67
    v_mul_f32 v248, v168, v64
    v_mul_f32 v249, v169, v65
    v_mul_f32 v250, v170, v66
    v_mul_f32 v251, v171, v67
    s_waitcnt lgkmcnt(10)
    v_fmac_f32 v240, v168, v68
    v_fmac_f32 v241, v169, v69
    v_fmac_f32 v242, v170, v70
    v_fmac_f32 v243, v171, v71
    v_fma_f32 v248, -v152, v68, v248
    v_fma_f32 v249, -v153, v69, v249
    v_fma_f32 v250, -v154, v70, v250
    v_fma_f32 v251, -v155, v71, v251
    v_cvt_pk_bf16_f32 v24, v240, v248
    v_cvt_pk_bf16_f32 v25, v241, v249
    v_cvt_pk_bf16_f32 v26, v242, v250
    v_cvt_pk_bf16_f32 v27, v243, v251
    s_waitcnt lgkmcnt(9)
    v_mul_f32 v240, v156, v72
    v_mul_f32 v241, v157, v73
    v_mul_f32 v242, v158, v74
    v_mul_f32 v243, v159, v75
    v_mul_f32 v248, v172, v72
    v_mul_f32 v249, v173, v73
    v_mul_f32 v250, v174, v74
    v_mul_f32 v251, v175, v75
    s_waitcnt lgkmcnt(8)
    v_fmac_f32 v240, v172, v76
    v_fmac_f32 v241, v173, v77
    v_fmac_f32 v242, v174, v78
    v_fmac_f32 v243, v175, v79
    v_fma_f32 v248, -v156, v76, v248
    v_fma_f32 v249, -v157, v77, v249
    v_fma_f32 v250, -v158, v78, v250
    v_fma_f32 v251, -v159, v79, v251
    v_cvt_pk_bf16_f32 v28, v240, v248
    v_cvt_pk_bf16_f32 v29, v241, v249
    v_cvt_pk_bf16_f32 v30, v242, v250
    v_cvt_pk_bf16_f32 v31, v243, v251
    v_mfma_f32_32x32x16_bf16 v[144:159], v[80:83], v[16:19], 0
    v_mfma_f32_32x32x16_bf16 v[160:175], v[84:87], v[16:19], 0
    v_mfma_f32_32x32x16_bf16 v[144:159], v[88:91], v[20:23], v[144:159]
    v_mfma_f32_32x32x16_bf16 v[160:175], v[92:95], v[20:23], v[160:175]
    v_mfma_f32_32x32x16_bf16 v[144:159], v[96:99], v[24:27], v[144:159]
    v_mfma_f32_32x32x16_bf16 v[160:175], v[100:103], v[24:27], v[160:175]
    v_mfma_f32_32x32x16_bf16 v[144:159], v[104:107], v[28:31], v[144:159]
    v_mfma_f32_32x32x16_bf16 v[160:175], v[108:111], v[28:31], v[160:175]
    s_waitcnt lgkmcnt(7)
    v_mul_f32 v240, v176, v208
    v_mul_f32 v241, v177, v209
    v_mul_f32 v242, v178, v210
    v_mul_f32 v243, v179, v211
    v_mul_f32 v248, v192, v208
    v_mul_f32 v249, v193, v209
    v_mul_f32 v250, v194, v210
    v_mul_f32 v251, v195, v211
    s_waitcnt lgkmcnt(6)
    v_fmac_f32 v240, v192, v212
    v_fmac_f32 v241, v193, v213
    v_fmac_f32 v242, v194, v214
    v_fmac_f32 v243, v195, v215
    v_fma_f32 v248, -v176, v212, v248
    v_fma_f32 v249, -v177, v213, v249
    v_fma_f32 v250, -v178, v214, v250
    v_fma_f32 v251, -v179, v215, v251
    v_cvt_pk_bf16_f32 v32, v240, v248
    v_cvt_pk_bf16_f32 v33, v241, v249
    v_cvt_pk_bf16_f32 v34, v242, v250
    v_cvt_pk_bf16_f32 v35, v243, v251
    s_waitcnt lgkmcnt(5)
    v_mul_f32 v240, v180, v216
    v_mul_f32 v241, v181, v217
    v_mul_f32 v242, v182, v218
    v_mul_f32 v243, v183, v219
    v_mul_f32 v248, v196, v216
    v_mul_f32 v249, v197, v217
    v_mul_f32 v250, v198, v218
    v_mul_f32 v251, v199, v219
    s_waitcnt lgkmcnt(4)
    v_fmac_f32 v240, v196, v220
    v_fmac_f32 v241, v197, v221
    v_fmac_f32 v242, v198, v222
    v_fmac_f32 v243, v199, v223
    v_fma_f32 v248, -v180, v220, v248
    v_fma_f32 v249, -v181, v221, v249
    v_fma_f32 v250, -v182, v222, v250
    v_fma_f32 v251, -v183, v223, v251
    v_cvt_pk_bf16_f32 v36, v240, v248
    v_cvt_pk_bf16_f32 v37, v241, v249
    v_cvt_pk_bf16_f32 v38, v242, v250
    v_cvt_pk_bf16_f32 v39, v243, v251
    s_waitcnt lgkmcnt(3)
    v_mul_f32 v240, v184, v224
    v_mul_f32 v241, v185, v225
    v_mul_f32 v242, v186, v226
    v_mul_f32 v243, v187, v227
    v_mul_f32 v248, v200, v224
    v_mul_f32 v249, v201, v225
    v_mul_f32 v250, v202, v226
    v_mul_f32 v251, v203, v227
    s_waitcnt lgkmcnt(2)
    v_fmac_f32 v240, v200, v228
    v_fmac_f32 v241, v201, v229
    v_fmac_f32 v242, v202, v230
    v_fmac_f32 v243, v203, v231
    v_fma_f32 v248, -v184, v228, v248
    v_fma_f32 v249, -v185, v229, v249
    v_fma_f32 v250, -v186, v230, v250
    v_fma_f32 v251, -v187, v231, v251
    v_cvt_pk_bf16_f32 v40, v240, v248
    v_cvt_pk_bf16_f32 v41, v241, v249
    v_cvt_pk_bf16_f32 v42, v242, v250
    v_cvt_pk_bf16_f32 v43, v243, v251
    s_waitcnt lgkmcnt(1)
    v_mul_f32 v240, v188, v232
    v_mul_f32 v241, v189, v233
    v_mul_f32 v242, v190, v234
    v_mul_f32 v243, v191, v235
    v_mul_f32 v248, v204, v232
    v_mul_f32 v249, v205, v233
    v_mul_f32 v250, v206, v234
    v_mul_f32 v251, v207, v235
    s_waitcnt lgkmcnt(0)
    v_fmac_f32 v240, v204, v236
    v_fmac_f32 v241, v205, v237
    v_fmac_f32 v242, v206, v238
    v_fmac_f32 v243, v207, v239
    v_fma_f32 v248, -v188, v236, v248
    v_fma_f32 v249, -v189, v237, v249
    v_fma_f32 v250, -v190, v238, v250
    v_fma_f32 v251, -v191, v239, v251
    v_cvt_pk_bf16_f32 v44, v240, v248
    v_cvt_pk_bf16_f32 v45, v241, v249
    v_cvt_pk_bf16_f32 v46, v242, v250
    v_cvt_pk_bf16_f32 v47, v243, v251
    v_mfma_f32_32x32x16_bf16 v[176:191], v[80:83], v[32:35], 0
    v_mfma_f32_32x32x16_bf16 v[192:207], v[84:87], v[32:35], 0
    v_mfma_f32_32x32x16_bf16 v[176:191], v[88:91], v[36:39], v[176:191]
    v_mfma_f32_32x32x16_bf16 v[192:207], v[92:95], v[36:39], v[192:207]
    v_mfma_f32_32x32x16_bf16 v[176:191], v[96:99], v[40:43], v[176:191]
    v_mfma_f32_32x32x16_bf16 v[192:207], v[100:103], v[40:43], v[192:207]
    v_mfma_f32_32x32x16_bf16 v[176:191], v[104:107], v[44:47], v[176:191]
    v_mfma_f32_32x32x16_bf16 v[192:207], v[108:111], v[44:47], v[192:207]
    v_cvt_pk_bf16_f32 v144, v144, v160
    v_cvt_pk_bf16_f32 v145, v145, v161
    v_cvt_pk_bf16_f32 v146, v146, v162
    v_cvt_pk_bf16_f32 v147, v147, v163
    ds_write_b128 v2, v[144:147] offset:0
    v_cvt_pk_bf16_f32 v148, v148, v164
    v_cvt_pk_bf16_f32 v149, v149, v165
    v_cvt_pk_bf16_f32 v150, v150, v166
    v_cvt_pk_bf16_f32 v151, v151, v167
    ds_write_b128 v3, v[148:151] offset:0
    v_cvt_pk_bf16_f32 v152, v152, v168
    v_cvt_pk_bf16_f32 v153, v153, v169
    v_cvt_pk_bf16_f32 v154, v154, v170
    v_cvt_pk_bf16_f32 v155, v155, v171
    ds_write_b128 v4, v[152:155] offset:0
    v_cvt_pk_bf16_f32 v156, v156, v172
    v_cvt_pk_bf16_f32 v157, v157, v173
    v_cvt_pk_bf16_f32 v158, v158, v174
    v_cvt_pk_bf16_f32 v159, v159, v175
    ds_write_b128 v5, v[156:159] offset:0
    v_cvt_pk_bf16_f32 v176, v176, v192
    v_cvt_pk_bf16_f32 v177, v177, v193
    v_cvt_pk_bf16_f32 v178, v178, v194
    v_cvt_pk_bf16_f32 v179, v179, v195
    ds_write_b128 v2, v[176:179] offset:512
    v_cvt_pk_bf16_f32 v180, v180, v196
    v_cvt_pk_bf16_f32 v181, v181, v197
    v_cvt_pk_bf16_f32 v182, v182, v198
    v_cvt_pk_bf16_f32 v183, v183, v199
    ds_write_b128 v3, v[180:183] offset:512
    v_cvt_pk_bf16_f32 v184, v184, v200
    v_cvt_pk_bf16_f32 v185, v185, v201
    v_cvt_pk_bf16_f32 v186, v186, v202
    v_cvt_pk_bf16_f32 v187, v187, v203
    ds_write_b128 v4, v[184:187] offset:512
    v_cvt_pk_bf16_f32 v188, v188, v204
    v_cvt_pk_bf16_f32 v189, v189, v205
    v_cvt_pk_bf16_f32 v190, v190, v206
    v_cvt_pk_bf16_f32 v191, v191, v207
    ds_write_b128 v5, v[188:191] offset:512
T_X:
    s_waitcnt lgkmcnt(0)
    s_barrier
    ds_read2st64_b32 v[16:17], v6 offset0:0 offset1:32
    ds_read2st64_b32 v[18:19], v6 offset0:64 offset1:96
    ds_read2st64_b32 v[20:21], v7 offset0:0 offset1:32
    ds_read2st64_b32 v[22:23], v7 offset0:64 offset1:96
    ds_read2st64_b32 v[24:25], v8 offset0:0 offset1:32
    ds_read2st64_b32 v[26:27], v8 offset0:64 offset1:96
    ds_read2st64_b32 v[28:29], v9 offset0:0 offset1:32
    ds_read2st64_b32 v[30:31], v9 offset0:64 offset1:96
    ds_read2st64_b32 v[32:33], v6 offset0:2 offset1:34
    ds_read2st64_b32 v[34:35], v6 offset0:66 offset1:98
    ds_read2st64_b32 v[36:37], v7 offset0:2 offset1:34
    ds_read2st64_b32 v[38:39], v7 offset0:66 offset1:98
    ds_read2st64_b32 v[40:41], v8 offset0:2 offset1:34
    ds_read2st64_b32 v[42:43], v8 offset0:66 offset1:98
    ds_read2st64_b32 v[44:45], v9 offset0:2 offset1:34
    ds_read2st64_b32 v[46:47], v9 offset0:66 offset1:98
    s_add_u32 s65, s65, 12582912
    s_add_u32 s73, s73, 12582912
    s_waitcnt lgkmcnt(14)
    buffer_store_dwordx4 v[16:19], v1, s[40:43], s65 offen offset:0 sc1
    s_waitcnt lgkmcnt(12)
    buffer_store_dwordx4 v[20:23], v1, s[40:43], s65 offen offset:1024 sc1
    s_waitcnt lgkmcnt(10)
    buffer_store_dwordx4 v[24:27], v1, s[40:43], s65 offen offset:2048 sc1
    s_waitcnt lgkmcnt(8)
    buffer_store_dwordx4 v[28:31], v1, s[40:43], s65 offen offset:3072 sc1
    s_waitcnt lgkmcnt(6)
    buffer_store_dwordx4 v[32:35], v1, s[40:43], s73 offen offset:0 sc1
    s_waitcnt lgkmcnt(4)
    buffer_store_dwordx4 v[36:39], v1, s[40:43], s73 offen offset:1024 sc1
    s_waitcnt lgkmcnt(2)
    buffer_store_dwordx4 v[40:43], v1, s[40:43], s73 offen offset:2048 sc1
    s_waitcnt lgkmcnt(0)
    buffer_store_dwordx4 v[44:47], v1, s[40:43], s73 offen offset:3072 sc1
T_FIN:
    s_endpgm
K_END:
    s_endpgm
CODE_END:
spin_2:
    s_sleep 1
    s_bfe_u32 s70, s6, 0x80000
    s_lshl_b32 s70, s70, 11
    s_add_u32 s70, s70, s62
    s_add_u32 s70, s70, 57344
    buffer_load_dwordx4 v[112:115], v1, s[40:43], s70 offen offset:0 sc1
    buffer_load_dwordx4 v[120:123], v1, s[40:43], s70 offen offset:1024 sc1
    s_add_u32 s70, s70, 114688
    buffer_load_dwordx4 v[116:119], v1, s[40:43], s70 offen offset:0 sc1
    buffer_load_dwordx4 v[124:127], v1, s[40:43], s70 offen offset:1024 sc1
    s_waitcnt vmcnt(1)
    v_max3_u32 v15, v115, v119, v123
    s_waitcnt vmcnt(0)
    v_max_u32 v15, v15, v127
    s_waitcnt vmcnt(0)
    s_add_u32 s63, s63, 1
    s_cmp_ge_u32 s63, 0x4000
    s_cbranch_scc1 ok_1
    v_cmp_eq_u32 vcc, -1, v15
    s_cbranch_vccnz spin_2
    s_branch ok_1
spin_4:
    s_sleep 1
    s_bfe_u32 s70, s6, 0x80008
    s_lshl_b32 s70, s70, 11
    s_add_u32 s70, s70, s62
    s_add_u32 s70, s70, 57344
    buffer_load_dwordx4 v[128:131], v1, s[40:43], s70 offen offset:0 sc1
    buffer_load_dwordx4 v[136:139], v1, s[40:43], s70 offen offset:1024 sc1
    s_add_u32 s70, s70, 114688
    buffer_load_dwordx4 v[132:135], v1, s[40:43], s70 offen offset:0 sc1
    buffer_load_dwordx4 v[140:143], v1, s[40:43], s70 offen offset:1024 sc1
    s_waitcnt vmcnt(1)
    v_max3_u32 v15, v131, v135, v139
    s_waitcnt vmcnt(0)
    v_max_u32 v15, v15, v143
    s_waitcnt vmcnt(0)
    s_add_u32 s63, s63, 1
    s_cmp_ge_u32 s63, 0x4000
    s_cbranch_scc1 ok_3
    v_cmp_eq_u32 vcc, -1, v15
    s_cbranch_vccnz spin_4
    s_branch ok_3
spin_6:
    s_sleep 1
    s_bfe_u32 s70, s6, 0x80010
    s_lshl_b32 s70, s70, 11
    s_add_u32 s70, s70, s62
    s_add_u32 s70, s70, 57344
    buffer_load_dwordx4 v[144:147], v1, s[40:43], s70 offen offset:0 sc1
    buffer_load_dwordx4 v[152:155], v1, s[40:43], s70 offen offset:1024 sc1
    s_add_u32 s70, s70, 114688
    buffer_load_dwordx4 v[148:151], v1, s[40:43], s70 offen offset:0 sc1
    buffer_load_dwordx4 v[156:159], v1, s[40:43], s70 offen offset:1024 sc1
    s_waitcnt vmcnt(1)
    v_max3_u32 v15, v147, v151, v155
    s_waitcnt vmcnt(0)
    v_max_u32 v15, v15, v159
    s_waitcnt vmcnt(0)
    s_add_u32 s63, s63, 1
    s_cmp_ge_u32 s63, 0x4000
    s_cbranch_scc1 ok_5
    v_cmp_eq_u32 vcc, -1, v15
    s_cbranch_vccnz spin_6
    s_branch ok_5
spin_8:
    s_sleep 1
    s_bfe_u32 s70, s6, 0x80018
    s_lshl_b32 s70, s70, 11
    s_add_u32 s70, s70, s62
    s_add_u32 s70, s70, 57344
    buffer_load_dwordx4 v[160:163], v1, s[40:43], s70 offen offset:0 sc1
    buffer_load_dwordx4 v[168:171], v1, s[40:43], s70 offen offset:1024 sc1
    s_add_u32 s70, s70, 114688
    buffer_load_dwordx4 v[164:167], v1, s[40:43], s70 offen offset:0 sc1
    buffer_load_dwordx4 v[172:175], v1, s[40:43], s70 offen offset:1024 sc1
    s_waitcnt vmcnt(1)
    v_max3_u32 v15, v163, v167, v171
    s_waitcnt vmcnt(0)
    v_max_u32 v15, v15, v175
    s_waitcnt vmcnt(0)
    s_add_u32 s63, s63, 1
    s_cmp_ge_u32 s63, 0x4000
    s_cbranch_scc1 ok_7
    v_cmp_eq_u32 vcc, -1, v15
    s_cbranch_vccnz spin_8
    s_branch ok_7
spin_10:
    s_sleep 1
    s_bfe_u32 s70, s7, 0x80000
    s_lshl_b32 s70, s70, 11
    s_add_u32 s70, s70, s62
    s_add_u32 s70, s70, 57344
    buffer_load_dwordx4 v[176:179], v1, s[40:43], s70 offen offset:0 sc1
    buffer_load_dwordx4 v[184:187], v1, s[40:43], s70 offen offset:1024 sc1
    s_add_u32 s70, s70, 114688
    buffer_load_dwordx4 v[180:183], v1, s[40:43], s70 offen offset:0 sc1
    buffer_load_dwordx4 v[188:191], v1, s[40:43], s70 offen offset:1024 sc1
    s_waitcnt vmcnt(1)
    v_max3_u32 v15, v179, v183, v187
    s_waitcnt vmcnt(0)
    v_max_u32 v15, v15, v191
    s_waitcnt vmcnt(0)
    s_add_u32 s63, s63, 1
    s_cmp_ge_u32 s63, 0x4000
    s_cbranch_scc1 ok_9
    v_cmp_eq_u32 vcc, -1, v15
    s_cbranch_vccnz spin_10
    s_branch ok_9
spin_12:
    s_sleep 1
    s_bfe_u32 s70, s7, 0x80008
    s_lshl_b32 s70, s70, 11
    s_add_u32 s70, s70, s62
    s_add_u32 s70, s70, 57344
    buffer_load_dwordx4 v[192:195], v1, s[40:43], s70 offen offset:0 sc1
    buffer_load_dwordx4 v[200:203], v1, s[40:43], s70 offen offset:1024 sc1
    s_add_u32 s70, s70, 114688
    buffer_load_dwordx4 v[196:199], v1, s[40:43], s70 offen offset:0 sc1
    buffer_load_dwordx4 v[204:207], v1, s[40:43], s70 offen offset:1024 sc1
    s_waitcnt vmcnt(1)
    v_max3_u32 v15, v195, v199, v203
    s_waitcnt vmcnt(0)
    v_max_u32 v15, v15, v207
    s_waitcnt vmcnt(0)
    s_add_u32 s63, s63, 1
    s_cmp_ge_u32 s63, 0x4000
    s_cbranch_scc1 ok_11
    v_cmp_eq_u32 vcc, -1, v15
    s_cbranch_vccnz spin_12
    s_branch ok_11
spin_14:
    s_sleep 1
    s_bfe_u32 s70, s7, 0x80010
    s_lshl_b32 s70, s70, 11
    s_add_u32 s70, s70, s62
    s_add_u32 s70, s70, 57344
    buffer_load_dwordx4 v[208:211], v1, s[40:43], s70 offen offset:0 sc1
    buffer_load_dwordx4 v[216:219], v1, s[40:43], s70 offen offset:1024 sc1
    s_add_u32 s70, s70, 114688
    buffer_load_dwordx4 v[212:215], v1, s[40:43], s70 offen offset:0 sc1
    buffer_load_dwordx4 v[220:223], v1, s[40:43], s70 offen offset:1024 sc1
    s_waitcnt vmcnt(1)
    v_max3_u32 v15, v211, v215, v219
    s_waitcnt vmcnt(0)
    v_max_u32 v15, v15, v223
    s_waitcnt vmcnt(0)
    s_add_u32 s63, s63, 1
    s_cmp_ge_u32 s63, 0x4000
    s_cbranch_scc1 ok_13
    v_cmp_eq_u32 vcc, -1, v15
    s_cbranch_vccnz spin_14
    s_branch ok_13
spin_16:
    s_sleep 1
    buffer_load_dword v244, v249, s[40:43], s72 offen offset:0 sc1
    s_waitcnt vmcnt(0)
    s_add_u32 s63, s63, 1
    s_cmp_ge_u32 s63, 0x4000
    s_cbranch_scc1 ok_15
    v_cmp_eq_u32 vcc, -1, v244
    s_cbranch_vccnz spin_16
    s_branch ok_15
spin_20:
    s_sleep 1
    buffer_load_dword v12, v6, s[40:43], s8 offen offset:8 sc1
    s_waitcnt vmcnt(0)
    s_add_u32 s63, s63, 1
    s_cmp_ge_u32 s63, 0x4000
    s_cbranch_scc1 ok_19
    v_cmp_ne_u32 vcc, s59, v12
    s_cbranch_vccnz spin_20
    s_branch ok_19
spin_22:
    s_sleep 1
    s_add_u32 s70, s11, 0
    buffer_load_dwordx4 v[148:151], v1, s[40:43], s70 offen offset:0 sc1
    s_add_u32 s70, s11, 262144
    buffer_load_dwordx4 v[152:155], v1, s[40:43], s70 offen offset:0 sc1
    s_add_u32 s70, s11, 524288
    buffer_load_dwordx4 v[156:159], v1, s[40:43], s70 offen offset:0 sc1
    s_add_u32 s70, s11, 786432
    buffer_load_dwordx4 v[192:195], v1, s[40:43], s70 offen offset:0 sc1
    s_waitcnt vmcnt(1)
    v_max3_u32 v15, v151, v155, v159
    s_waitcnt vmcnt(0)
    v_max_u32 v15, v15, v195
    s_waitcnt vmcnt(0)
    s_add_u32 s63, s63, 1
    s_cmp_ge_u32 s63, 0x4000
    s_cbranch_scc1 ok_21
    v_cmp_eq_u32 vcc, -1, v15
    s_cbranch_vccnz spin_22
    s_branch ok_21
spin_24:
    s_sleep 1
    s_add_u32 s70, s11, 1048576
    buffer_load_dwordx4 v[196:199], v1, s[40:43], s70 offen offset:0 sc1
    s_add_u32 s70, s11, 1310720
    buffer_load_dwordx4 v[200:203], v1, s[40:43], s70 offen offset:0 sc1
    s_add_u32 s70, s11, 1572864
    buffer_load_dwordx4 v[204:207], v1, s[40:43], s70 offen offset:0 sc1
    s_waitcnt vmcnt(0)
    v_max3_u32 v15, v199, v203, v207
    v_max_u32 v15, v15, v207
    s_waitcnt vmcnt(0)
    s_add_u32 s63, s63, 1
    s_cmp_ge_u32 s63, 0x4000
    s_cbranch_scc1 ok_23
    v_cmp_eq_u32 vcc, -1, v15
    s_cbranch_vccnz spin_24
    s_branch ok_23
spin_26:
    s_sleep 1
    s_add_u32 s70, s11, 0
    buffer_load_dwordx4 v[160:163], v1, s[40:43], s70 offen offset:1024 sc1
    s_add_u32 s70, s11, 262144
    buffer_load_dwordx4 v[164:167], v1, s[40:43], s70 offen offset:1024 sc1
    s_add_u32 s70, s11, 524288
    buffer_load_dwordx4 v[168:171], v1, s[40:43], s70 offen offset:1024 sc1
    s_add_u32 s70, s11, 786432
    buffer_load_dwordx4 v[172:175], v1, s[40:43], s70 offen offset:1024 sc1
    s_waitcnt vmcnt(1)
    v_max3_u32 v15, v163, v167, v171
    s_waitcnt vmcnt(0)
    v_max_u32 v15, v15, v175
    s_waitcnt vmcnt(0)
    s_add_u32 s63, s63, 1
    s_cmp_ge_u32 s63, 0x4000
    s_cbranch_scc1 ok_25
    v_cmp_eq_u32 vcc, -1, v15
    s_cbranch_vccnz spin_26
    s_branch ok_25
spin_28:
    s_sleep 1
    s_add_u32 s70, s11, 1048576
    buffer_load_dwordx4 v[208:211], v1, s[40:43], s70 offen offset:1024 sc1
    s_add_u32 s70, s11, 1310720
    buffer_load_dwordx4 v[212:215], v1, s[40:43], s70 offen offset:1024 sc1
    s_add_u32 s70, s11, 1572864
    buffer_load_dwordx4 v[216:219], v1, s[40:43], s70 offen offset:1024 sc1
    s_waitcnt vmcnt(0)
    v_max3_u32 v15, v211, v215, v219
    v_max_u32 v15, v15, v219
    s_waitcnt vmcnt(0)
    s_add_u32 s63, s63, 1
    s_cmp_ge_u32 s63, 0x4000
    s_cbranch_scc1 ok_27
    v_cmp_eq_u32 vcc, -1, v15
    s_cbranch_vccnz spin_28
    s_branch ok_27
spin_30:
    s_sleep 1
    buffer_load_dword v222, v225, s[40:43], s72 offen offset:1024 sc1
    s_waitcnt vmcnt(0)
    s_add_u32 s63, s63, 1
    s_cmp_ge_u32 s63, 0x4000
    s_cbranch_scc1 ok_29
    v_cmp_eq_u32 vcc, -1, v222
    s_cbranch_vccnz spin_30
    s_branch ok_29
spin_33:
    s_sleep 4
    buffer_load_dword v12, v10, s[40:43], s66 offen offset:8 sc1
    s_waitcnt vmcnt(0)
    s_add_u32 s63, s63, 1
    s_cmp_ge_u32 s63, 0x4000
    s_cbranch_scc1 ok_32
    v_cmp_ne_u32 vcc, s59, v12
    s_cbranch_vccnz spin_33
    s_branch ok_32
spin_35:
    s_sleep 1
    buffer_load_dword v12, v13, s[40:43], s72 offen offset:8 sc1
    s_waitcnt vmcnt(0)
    s_add_u32 s63, s63, 1
    s_cmp_ge_u32 s63, 0x4000
    s_cbranch_scc1 ok_34
    v_cmp_ne_u32 vcc, s59, v12
    s_cbranch_vccnz spin_35
    s_branch ok_34
.section .rodata,"a"
.p2align 6
.amdhsa_kernel parallel_sum__spectral_gfnet__glu_gated_bilinear__prompt_kernel
  .amdhsa_next_free_vgpr 256
  .amdhsa_next_free_sgpr 102
  .amdhsa_accum_offset 256
  .amdhsa_group_segment_fixed_size 0
  .amdhsa_kernarg_size 80
  .amdhsa_user_sgpr_count 2
  .amdhsa_user_sgpr_kernarg_segment_ptr 1
  .amdhsa_system_sgpr_workgroup_id_x 1
  .amdhsa_float_denorm_mode_32 3
  .amdhsa_float_denorm_mode_16_64 3
.end_amdhsa_kernel
```
